```python
import torch

def _softmax(x, axis=-1):
    return torch.softmax(x, dim=axis)
def _gelu(x):
    return torch.nn.functional.gelu(x, approximate="tanh")
def _silu(x):
    return torch.nn.functional.silu(x)
def _sigmoid(x):
    return torch.sigmoid(x)
def _layernorm(x, axis=-1, eps=1e-5):
    m = x.mean(dim=axis, keepdim=True)
    v = x.var(dim=axis, keepdim=True, unbiased=False)
    return (x - m) / torch.sqrt(v + eps)
def _scatter_add(tgt, idx, src, axis=0):
    return tgt.clone().index_add_(axis, idx, src)
def _segment_sum(src, seg, n):
    out = torch.zeros((n,) + src.shape[1:], dtype=src.dtype)
    return out.index_add_(0, seg, src)
def _pad(x, pw):
    flat = tuple(v for pair in reversed(pw) for v in pair)
    return torch.nn.functional.pad(x, flat)

kernel_name = 'sequential_preLN__ssm_conv_h3__mixer_channel_mlp__prompt'

def setup_inputs():

    _w = (lambda a: (lambda t: t.to(torch.bfloat16) if t.is_floating_point() else t)(torch.as_tensor(a)))
    def _A_setup():
        B, S, D = 1, 2048, 448
        ks = 4
        return {
            "q": _w((lambda *s: torch.randn(*s, dtype=torch.bfloat16) * 0.05)(B, S, D)),
            "k": _w((lambda *s: torch.randn(*s, dtype=torch.bfloat16) * 0.2)(B, S, D)),
            "v": _w((lambda *s: torch.randn(*s, dtype=torch.bfloat16) * 0.2)(B, S, D)),
            "shift_k": _w((lambda *s: torch.randn(*s, dtype=torch.bfloat16) * 0.2)(D, ks) * 0.5),
            "ssm_k": _w((lambda *s: torch.randn(*s, dtype=torch.bfloat16) * 0.8)(D, S) * (1.0 / S ** 0.5)),
            "ssm_D": _w((lambda *s: torch.randn(*s, dtype=torch.bfloat16) * 0.2)(D)),
        }
    _A_in = _A_setup()

    def _B_setup():
        B, S, D, F = 1, 2048, 448, 1792
        return {
            "x": _w((lambda *s: torch.randn(*s, dtype=torch.bfloat16) * 0.05)(B, S, D)),
            "w1": _w((lambda *s: torch.randn(*s, dtype=torch.bfloat16) * 0.8)(D, F) * (D ** -0.5)),
            "b1": _w((lambda *s: torch.randn(*s, dtype=torch.bfloat16) * 0.4)(F)),
            "w2": _w((lambda *s: torch.randn(*s, dtype=torch.bfloat16) * 0.05)(F, D) * (F ** -0.5)),
            "b2": _w((lambda *s: torch.randn(*s, dtype=torch.bfloat16) * 0.05)(D)),
        }
    _B_in = _B_setup()

    return {
        "A_q": _A_in["q"],
        "A_k": _A_in["k"],
        "A_v": _A_in["v"],
        "A_shift_k": _A_in["shift_k"],
        "A_ssm_k": _A_in["ssm_k"],
        "A_ssm_D": _A_in["ssm_D"],
        "B_x": _B_in["x"],
        "B_w1": _B_in["w1"],
        "B_b1": _B_in["b1"],
        "B_w2": _B_in["w2"],
        "B_b2": _B_in["b2"],
    }

def reference(A_q, A_k, A_v, A_shift_k, A_ssm_k, A_ssm_D, B_x, B_w1, B_b1, B_w2, B_b2):
    def _A_ref(q, k, v, shift_k, ssm_k, ssm_D):
        B, S, D = q.shape
        ks = shift_k.shape[-1]
        k_pad = _pad(k, ((0, 0), (ks - 1, 0), (0, 0)))
        k_shift = torch.zeros_like(k)
        for t in range(ks):
            k_shift = k_shift + k_pad[:, t:t + S, :] * shift_k[:, ks - 1 - t][None, None, :]
        kv = k_shift * v
        L = 2 * S
        kv_pad = _pad(kv, ((0, 0), (0, S), (0, 0)))
        kf_pad = _pad(ssm_k, ((0, 0), (0, S)))
        kv_f = (lambda x, axes=(-2,-1): torch.fft.rfft2(x.float(), dim=axes))(kv_pad[:, None, :, :], axes=(1, 2))
        kf_f = (lambda x, axes=(-2,-1): torch.fft.rfft2(x.float(), dim=axes))(kf_pad[:, None, :], axes=(1, 2))
        kf_f = (lambda x, *d: x.permute(*d))(kf_f, 1, 2, 0)
        y_f = kv_f * kf_f[None, :, :, :]
        y = (lambda x, s, axes=(-2,-1): torch.fft.irfft2(x, s=s, dim=axes).to(torch.bfloat16))(y_f, (1, L), axes=(1, 2))[:, 0, :S, :]
        y = y + kv * ssm_D[None, None, :]
        return q * y

    def _B_ref(x, w1, b1, w2, b2):
        y = _layernorm(x, axis=-1)
        h = _gelu(torch.einsum("bsd,df->bsf", y, w1) + b1)
        return torch.einsum("bsf,fd->bsd", h, w2) + b2

    x = A_q
    h = x + _A_ref(_layernorm(x, axis=-1), A_k, A_v, A_shift_k, A_ssm_k, A_ssm_D)
    h2 = h + _B_ref(_layernorm(h, axis=-1), B_w1, B_b1, B_w2, B_b2)
    return h2
```

```asm
; @launch grid=(256,1,1) block=(512,1,1) lds=163840
.amdgcn_target "amdgcn-amd-amdhsa--gfx950"
.text
.globl sequential_preLN__ssm_conv_h3__mixer_channel_mlp__prompt_kernel
.p2align 8
.type sequential_preLN__ssm_conv_h3__mixer_channel_mlp__prompt_kernel,@function
sequential_preLN__ssm_conv_h3__mixer_channel_mlp__prompt_kernel:
CODE_BEG:
    s_cmp_ge_u32 s2, 256
    s_cbranch_scc1 END
    s_load_dwordx4 s[4:7], s[0:1], 0
    s_load_dwordx4 s[8:11], s[0:1], 16
    s_load_dwordx2 s[12:13], s[0:1], 104
    s_load_dwordx4 s[64:67], s[0:1], 32
    s_and_b32 s52, s2, 7
    s_lshr_b32 s53, s2, 3
    v_and_b32 v1, 63, v0
    v_lshrrev_b32 v4, 6, v0
    v_lshlrev_b32 v2, 4, v1
    v_readfirstlane_b32 s54, v4
    v_lshrrev_b32 v5, 3, v1
    v_mul_u32_u24 v5, 896, v5
    v_and_b32 v6, 7, v1
    v_lshlrev_b32 v6, 4, v6
    v_bfe_u32 v3, v1, 4, 1
    v_lshlrev_b32 v3, 4, v3
    v_xor_b32 v6, v6, v3
    v_add_u32 v3, v5, v6
    s_mul_i32 s58, s53, 57344
    s_lshl_b32 s59, s52, 7
    s_add_u32 s58, s58, s59
    v_add_u32 v3, s58, v3
    s_mul_i32 s61, s54, 7168
    s_mul_i32 s62, s54, 1056
    s_lshl_b32 s55, s52, 5
    s_add_u32 s55, s55, s53
    s_mov_b32 s59, 13697024
    s_cmp_eq_u32 s52, 7
    s_waitcnt lgkmcnt(0)
    s_load_dword s3, s[12:13], s59
    s_mov_b32 s24, s4
    s_and_b32 s25, s5, 0xffff
    s_mov_b32 s26, 1835008
    s_mov_b32 s27, 0x20000
    s_mov_b32 s16, s6
    s_and_b32 s17, s7, 0xffff
    s_mov_b32 s18, 1835008
    s_mov_b32 s19, 0x20000
    s_mov_b32 s20, s8
    s_and_b32 s21, s9, 0xffff
    s_mov_b32 s22, 1835008
    s_mov_b32 s23, 0x20000
    s_cmp_eq_u32 s52, 7
    s_cbranch_scc1 XSTAT
    s_cmp_lg_u32 s54, 0
    s_cbranch_scc1 P1_NH
    v_add_u32 v4, 4294960128, v3
    s_mov_b32 m0, 42496
    s_nop 0
    buffer_load_dwordx4 v4, s[16:19], 0 offen lds
P1_NH:
    s_add_u32 m0, s62, 43552
    s_nop 0
    buffer_load_dwordx4 v3, s[16:19], s61 offen lds
    s_add_u32 m0, s62, 52000
    s_nop 0
    buffer_load_dwordx4 v3, s[20:23], s61 offen lds
    s_add_u32 m0, s62, 60448
    s_mov_b32 s44, s10
    s_and_b32 s45, s11, 0xffff
    s_mov_b32 s46, 3584
    s_mov_b32 s47, 0x20000
    buffer_load_dwordx4 v3, s[24:27], s61 offen lds
    v_bfe_u32 v4, v1, 4, 1
    v_and_b32 v5, 3, v1
    v_lshl_add_u32 v8, v4, 2, v5
    s_lshl_b32 s59, s54, 3
    v_add_u32 v8, s59, v8
    s_lshl_b32 s59, s52, 6
    v_add_lshl_u32 v4, v8, s59, 3
    buffer_load_dwordx2 v[10:11], v4, s[44:47], 0 offen
    s_mov_b32 s28, s12
    s_and_b32 s29, s13, 0xffff
    s_mov_b32 s30, 20971520
    s_mov_b32 s31, 0x20000
    s_waitcnt vmcnt(3)
    s_lshl_b32 s60, s55, 14
    s_lshl_b32 s62, s54, 11
    s_add_u32 s60, s60, s62
    buffer_load_dwordx4 v[24:27], v2, s[28:31], s60 offen
    buffer_load_dwordx4 v[24:27], v2, s[28:31], s60 offen offset:1024
    s_lshl_b32 s60, s52, 7
    s_add_u32 s60, s60, 13701120
    buffer_load_dword v24, v1, s[28:31], s60 offen sc1
    s_lshr_b32 s58, s54, 2
    s_and_b32 s59, s54, 3
    s_lshl_b32 s68, s55, 1
    s_add_u32 s68, s68, s58
    s_lshl_b32 s68, s68, 12
    s_add_u32 s64, s64, s68
    s_addc_u32 s65, s65, 0
    s_mov_b32 s32, s64
    s_and_b32 s33, s65, 0xffff
    s_mov_b32 s34, 4096
    s_mov_b32 s35, 0x20000
    s_lshl_b32 s59, s59, 10
    v_add_u32 v4, s59, v2
    v_add_u32 v5, -8, v4
    buffer_load_dwordx2 v[112:113], v5, s[32:35], 0 offen
    buffer_load_dwordx4 v[114:117], v4, s[32:35], 0 offen
    s_mul_i32 s58, s58, 16640
    s_add_u32 s58, s58, 32
    v_add_u32 v13, s58, v4
    s_lshl_b32 s68, s55, 2
    s_load_dword s14, s[66:67], s68
    s_load_dwordx4 s[4:7], s[0:1], 56
    s_load_dwordx4 s[8:11], s[0:1], 72
    s_load_dwordx2 s[64:65], s[0:1], 88
    s_lshl_b32 s63, s2, 3
    s_add_u32 s63, s63, s54
    s_mul_i32 s68, s63, 896
    v_add_u32 v7, s68, v2
    v_cmp_gt_u32 vcc, 56, v1
    v_mov_b32 v9, 0x80000000
    s_mov_b32 s15, 0x3f803f80
    v_cndmask_b32 v7, v9, v7, vcc
    v_mov_b32 v28, 0
    v_mov_b32 v29, 0
    buffer_load_dwordx4 v[16:19], v7, s[24:27], 0 offen
    v_lshrrev_b32 v4, 5, v1
    v_and_b32 v5, 3, v1
    v_lshl_add_u32 v6, v4, 2, v5
    v_mul_u32_u24 v20, 1056, v6
    v_bfe_u32 v5, v1, 2, 2
    v_lshl_add_u32 v20, v5, 7, v20
    v_lshrrev_b32 v6, 1, v5
    v_xor_b32 v6, s54, v6
    v_lshl_add_u32 v20, v6, 4, v20
    v_bfe_u32 v6, v1, 4, 1
    v_lshl_add_u32 v20, v6, 3, v20
    v_lshl_add_u32 v4, v4, 2, v5
    v_lshl_add_u32 v4, v8, 1, v4
    v_and_b32 v4, 7, v4
    v_lshlrev_b32 v4, 4, v4
    v_lshl_add_u32 v21, v8, 7, v4
    v_add_u32 v21, 68896, v21
    v_lshrrev_b32 v8, 3, v0
    v_and_b32 v5, 7, v0
    v_lshl_add_u32 v4, v8, 1, v5
    v_and_b32 v4, 7, v4
    v_lshlrev_b32 v4, 4, v4
    v_lshl_add_u32 v22, v8, 7, v4
    v_add_u32 v22, 68896, v22
    v_lshrrev_b32 v4, 1, v8
    v_lshlrev_b32 v4, 14, v4
    v_and_b32 v8, 1, v8
    v_lshl_add_u32 v4, v8, 12, v4
    v_lshl_add_u32 v4, v5, 4, v4
    s_lshl_b32 s58, s52, 19
    s_lshl_b32 s59, s53, 7
    s_add_u32 s58, s58, s59
    v_add_u32 v23, s58, v4
    s_mov_b32 s58, 0xffff0000
    s_mov_b32 s59, 8192
    v_mov_b32 v6, 0
    v_and_b32 v4, 15, v1
    v_lshlrev_b32 v4, 2, v4
    v_add_u32 v4, 161280, v4
    ds_write_b32 v4, v6
    s_mul_i32 s56, s53, 37
    s_lshr_b32 s56, s56, 8
    s_mul_i32 s57, s56, 7
    s_sub_u32 s57, s53, s57
    s_lshr_b32 s69, s54, 1
    s_add_u32 s69, s69, s56
    s_and_b32 s69, s69, 3
    s_lshl_b32 s60, s52, 2
    s_add_u32 s56, s56, s60
    s_lshl_b32 s68, s57, 3
    s_add_u32 s68, s68, s54
    s_waitcnt vmcnt(6)
    s_waitcnt lgkmcnt(0)
    s_mov_b32 s44, s10
    s_and_b32 s45, s11, 0xffff
    s_mov_b32 s46, 896
    s_mov_b32 s47, 0x20000
    buffer_load_dwordx4 v[24:27], v2, s[44:47], 0 offen
    s_barrier
    ds_read_b64_tr_b16 v[32:33], v20 offset:43008
    ds_read_b64_tr_b16 v[34:35], v20 offset:43552
    ds_read_b64_tr_b16 v[36:37], v20 offset:44064
    ds_read_b64_tr_b16 v[38:39], v20 offset:52000
    ds_read_b64_tr_b16 v[40:41], v20 offset:52512
    ds_read_b64_tr_b16 v[44:45], v20 offset:60448
    ds_read_b64_tr_b16 v[46:47], v20 offset:60960
    v_lshlrev_b32 v48, 16, v10
    v_and_b32 v49, s58, v10
    v_lshlrev_b32 v50, 16, v11
    v_and_b32 v51, s58, v11
    s_add_u32 s3, s3, 2654435769
    s_waitcnt lgkmcnt(4)
    v_and_b32 v52, s58, v32
    v_lshlrev_b32 v53, 16, v33
    v_and_b32 v54, s58, v33
    v_lshlrev_b32 v55, 16, v34
    v_and_b32 v56, s58, v34
    v_lshlrev_b32 v57, 16, v35
    v_and_b32 v58, s58, v35
    v_lshlrev_b32 v59, 16, v36
    v_and_b32 v60, s58, v36
    v_lshlrev_b32 v61, 16, v37
    v_and_b32 v62, s58, v37
    s_waitcnt lgkmcnt(0)
    ds_write_b128 v21, v[44:47] offset:8192
    v_lshlrev_b32 v72, 16, v38
    v_mul_f32 v64, v55, v48
    v_fmac_f32 v64, v54, v49
    v_fmac_f32 v64, v53, v50
    v_fmac_f32 v64, v52, v51
    v_mul_f32 v64, v64, v72
    v_and_b32 v73, s58, v38
    v_mul_f32 v65, v56, v48
    v_fmac_f32 v65, v55, v49
    v_fmac_f32 v65, v54, v50
    v_fmac_f32 v65, v53, v51
    v_mul_f32 v65, v65, v73
    v_lshlrev_b32 v72, 16, v39
    v_mul_f32 v66, v57, v48
    v_fmac_f32 v66, v56, v49
    v_fmac_f32 v66, v55, v50
    v_fmac_f32 v66, v54, v51
    v_mul_f32 v66, v66, v72
    v_and_b32 v73, s58, v39
    v_mul_f32 v67, v58, v48
    v_fmac_f32 v67, v57, v49
    v_fmac_f32 v67, v56, v50
    v_fmac_f32 v67, v55, v51
    v_mul_f32 v67, v67, v73
    v_lshlrev_b32 v72, 16, v40
    v_mul_f32 v68, v59, v48
    v_fmac_f32 v68, v58, v49
    v_fmac_f32 v68, v57, v50
    v_fmac_f32 v68, v56, v51
    v_mul_f32 v68, v68, v72
    v_and_b32 v73, s58, v40
    v_mul_f32 v69, v60, v48
    v_fmac_f32 v69, v59, v49
    v_fmac_f32 v69, v58, v50
    v_fmac_f32 v69, v57, v51
    v_mul_f32 v69, v69, v73
    v_lshlrev_b32 v72, 16, v41
    v_mul_f32 v70, v61, v48
    v_fmac_f32 v70, v60, v49
    v_fmac_f32 v70, v59, v50
    v_fmac_f32 v70, v58, v51
    v_mul_f32 v70, v70, v72
    v_and_b32 v73, s58, v41
    v_mul_f32 v71, v62, v48
    v_fmac_f32 v71, v61, v49
    v_fmac_f32 v71, v60, v50
    v_fmac_f32 v71, v59, v51
    v_mul_f32 v71, v71, v73
    v_cvt_pk_bf16_f32 v76, v71, v70
    v_cvt_pk_bf16_f32 v77, v69, v68
    v_cvt_pk_bf16_f32 v78, v67, v66
    v_cvt_pk_bf16_f32 v79, v65, v64
    ds_write_b128 v21, v[76:79]
    s_waitcnt lgkmcnt(0)
    s_barrier
    ds_read_b128 v[32:35], v22
    ds_read_b128 v[36:39], v22 offset:8192
    s_waitcnt lgkmcnt(1)
    buffer_store_dwordx4 v[32:35], v23, s[28:31], 0 offen
    s_waitcnt lgkmcnt(0)
    buffer_store_dwordx4 v[36:39], v23, s[28:31], s59 offen
    s_lshl_b32 s61, s52, 7
    s_add_u32 s61, s61, 13701120
    s_lshl_b32 s62, s53, 2
    s_add_u32 s62, s62, s61
    s_getreg_b32 s32, hwreg(HW_REG_XCC_ID, 0, 4)
    s_add_u32 s32, s32, s3
    s_add_u32 s32, s32, 1
    v_mov_b32 v30, s32
    s_cmp_lt_u32 s54, 4
    s_cbranch_scc1 EA_NO
    s_cmp_ge_u32 s53, 28
    s_cbranch_scc1 EA_NO
    s_nop 0
    s_mov_b32 s36, s4
    s_and_b32 s37, s5, 0xffff
    s_mov_b32 s38, 1605632
    s_mov_b32 s39, 0x20000
    s_mov_b32 s40, s8
    s_and_b32 s41, s9, 0xffff
    s_mov_b32 s42, 1605632
    s_mov_b32 s43, 0x20000
    s_mov_b32 s48, s64
    s_and_b32 s49, s65, 0xffff
    s_mov_b32 s50, 1835008
    s_mov_b32 s51, 0x20000
    v_lshrrev_b32 v5, 2, v1
    v_mul_u32_u24 v5, 3584, v5
    v_and_b32 v7, 3, v1
    v_lshl_add_u32 v3, v7, 4, v5
    s_lshl_b32 s58, s68, 6
    v_add_u32 v3, s58, v3
    v_bfe_u32 v5, v1, 2, 2
    v_lshrrev_b32 v12, 5, v1
    v_lshl_add_u32 v12, v12, 2, v5
    v_lshlrev_b32 v12, 6, v12
    v_bfe_u32 v5, v1, 4, 1
    v_lshl_add_u32 v12, v5, 5, v12
    v_lshl_add_u32 v12, v7, 3, v12
    s_xor_b32 s58, s54, 4
    s_mul_i32 s58, s58, 7168
    s_add_u32 s66, s58, 99840
    v_add_u32 v12, s66, v12
    s_mov_b32 s15, 0x3f803f80
    s_add_u32 s67, s69, 0
    s_and_b32 s67, s67, 3
    s_mul_i32 s67, s67, 401408
    s_add_u32 m0, s66, 0
    s_nop 0
    buffer_load_dwordx4 v3, s[36:39], s67 offen lds
    s_add_u32 m0, s66, 1024
    s_add_u32 s67, s67, 57344
    buffer_load_dwordx4 v3, s[36:39], s67 offen lds
    s_add_u32 m0, s66, 2048
    s_add_u32 s67, s67, 57344
    buffer_load_dwordx4 v3, s[36:39], s67 offen lds
    s_add_u32 m0, s66, 3072
    s_add_u32 s67, s67, 57344
    buffer_load_dwordx4 v3, s[36:39], s67 offen lds
    s_add_u32 m0, s66, 4096
    s_add_u32 s67, s67, 57344
    buffer_load_dwordx4 v3, s[36:39], s67 offen lds
    s_add_u32 m0, s66, 5120
    s_add_u32 s67, s67, 57344
    buffer_load_dwordx4 v3, s[36:39], s67 offen lds
    s_add_u32 m0, s66, 6144
    s_add_u32 s67, s67, 57344
    buffer_load_dwordx4 v3, s[36:39], s67 offen lds
    s_waitcnt vmcnt(7)
    s_branch EA_J
EA_NO:
    s_waitcnt vmcnt(0)
EA_J:
    s_barrier
    s_cmp_lg_u32 s54, 0
    s_cbranch_scc1 P1_NF
    s_mov_b64 exec, 1
    buffer_store_dword v30, v6, s[28:31], s62 offen
    s_mov_b64 exec, -1
P1_NF:
    v_dot2_f32_bf16 v28, v16, s15, v28
    v_dot2_f32_bf16 v29, v16, v16, v29
    v_dot2_f32_bf16 v28, v17, s15, v28
    v_dot2_f32_bf16 v29, v17, v17, v29
    v_dot2_f32_bf16 v28, v18, s15, v28
    v_dot2_f32_bf16 v29, v18, v18, v29
    v_dot2_f32_bf16 v28, v19, s15, v28
    v_dot2_f32_bf16 v29, v19, v19, v29
    s_nop 2
    v_add_f32_dpp v28, v28, v28 quad_perm:[1,0,3,2] row_mask:0xf bank_mask:0xf
    v_add_f32_dpp v29, v29, v29 quad_perm:[1,0,3,2] row_mask:0xf bank_mask:0xf
    s_nop 0
    v_add_f32_dpp v28, v28, v28 quad_perm:[2,3,0,1] row_mask:0xf bank_mask:0xf
    v_add_f32_dpp v29, v29, v29 quad_perm:[2,3,0,1] row_mask:0xf bank_mask:0xf
    s_nop 0
    v_add_f32_dpp v28, v28, v28 row_half_mirror row_mask:0xf bank_mask:0xf
    v_add_f32_dpp v29, v29, v29 row_half_mirror row_mask:0xf bank_mask:0xf
    s_nop 0
    v_add_f32_dpp v28, v28, v28 row_mirror row_mask:0xf bank_mask:0xf
    v_add_f32_dpp v29, v29, v29 row_mirror row_mask:0xf bank_mask:0xf
    s_nop 0
    v_add_f32_dpp v28, v28, v28 row_bcast:15 row_mask:0xa bank_mask:0xf
    v_add_f32_dpp v29, v29, v29 row_bcast:15 row_mask:0xa bank_mask:0xf
    s_nop 0
    v_add_f32_dpp v28, v28, v28 row_bcast:31 row_mask:0xc bank_mask:0xf
    v_add_f32_dpp v29, v29, v29 row_bcast:31 row_mask:0xc bank_mask:0xf
    s_nop 0
    v_mul_f32 v28, 0x3b124925, v28
    v_mul_f32 v29, 0x3b124925, v29
    v_fma_f32 v29, -v28, v28, v29
    v_max_f32 v29, 0, v29
    v_add_f32 v29, 0x3727c5ac, v29
    v_rsq_f32 v16, v29
    v_mov_b32 v18, s3
    v_mov_b32 v19, s3
    v_mul_f32 v17, -v28, v16
    s_lshl_b32 s63, s63, 4
    s_add_u32 s63, s63, 13631488
    s_mov_b32 exec_lo, 0
    s_mov_b32 exec_hi, 0x80000000
    buffer_store_dwordx4 v[16:19], v6, s[28:31], s63 offen sc1
    s_mov_b64 exec, -1
    v_alignbit_b32 v120, v113, v112, 16
    v_alignbit_b32 v121, v114, v113, 16
    v_alignbit_b32 v122, v115, v114, 16
    v_alignbit_b32 v123, v116, v115, 16
    v_mov_b32 v124, v113
    v_mov_b32 v125, v114
    v_mov_b32 v126, v115
    v_mov_b32 v127, v116
    v_alignbit_b32 v128, v114, v113, 16
    v_alignbit_b32 v129, v115, v114, 16
    v_alignbit_b32 v130, v116, v115, 16
    v_alignbit_b32 v131, v117, v116, 16
    ds_write_b128 v13, v[120:123]
    ds_write_b128 v13, v[124:127] offset:4160
    ds_write_b128 v13, v[128:131] offset:8320
    ds_write_b128 v13, v[114:117] offset:12480
    s_lshl_b32 s58, s55, 14
    s_lshl_b32 s59, s54, 10
    s_add_u32 s2, s58, s59
    s_lshr_b32 s63, s54, 2
    s_mul_i32 s63, s63, 512
    s_add_u32 s63, s63, s59
    s_add_u32 m0, s63, 33760
    v_and_b32 v10, 15, v1
    v_lshrrev_b32 v11, 4, v1
    s_bfe_u32 s58, s54, 0x10001
    s_and_b32 s63, s54, 1
    v_mov_b32 v19, 1
    s_cmp_ge_u32 s54, 4
    s_cbranch_scc1 SET_HI
    v_mov_b32 v8, 0
    v_mov_b32 v9, 0
    s_mul_i32 s60, s58, 4608
    v_lshl_add_u32 v7, v1, 3, s60
    s_mov_b32 exec_hi, 0x0fffffff
    ds_write_b64 v7, v[8:9] offset:33280
    v_lshrrev_b32 v7, 2, v1
    v_mul_u32_u24 v7, 4160, v7
    v_and_b32 v4, 3, v1
    v_lshl_add_u32 v7, v4, 3, v7
    s_mov_b32 exec_hi, 0
    ds_write_b64 v7, v[8:9] offset:0
    s_mov_b64 exec, -1
    v_and_b32 v4, 3, v10
    v_mul_u32_u24 v4, 4160, v4
    v_and_b32 v13, 12, v10
    v_lshlrev_b32 v13, 1, v13
    v_lshl_add_u32 v13, v11, 4, v13
    s_lshl_b32 s59, s63, 8
    s_mul_i32 s62, s58, 16640
    s_add_u32 s62, s62, s59
    s_add_u32 s62, s62, 8
    v_add3_u32 v14, v4, v13, s62
    v_lshlrev_b32 v20, 5, v10
    v_lshlrev_b32 v4, 4, v11
    v_sub_u32 v20, v20, v4
    s_add_u32 s62, s60, 33584
    s_sub_u32 s62, s62, s59
    v_add_u32 v20, s62, v20
    s_lshl_b32 s62, s54, 13
    s_add_u32 s62, s62, 67072
    v_add_u32 v24, s62, v2
    s_lshl_b32 s62, s54, 2
    s_add_u32 s62, s62, 161296
    v_mov_b32 v21, s62
    v_mov_b32 v22, 161328
    s_waitcnt lgkmcnt(0)
    s_barrier
    buffer_load_dwordx4 v2, s[28:31], s2 offen sc1 lds
    ds_read_b32 v15, v22
    s_waitcnt lgkmcnt(0)
    v_cmp_ne_u32 vcc, 0, v15
    s_cbranch_vccnz SLOW1
LO_BACK:
    s_waitcnt vmcnt(0)
    s_barrier
    s_setprio 3
    ds_read_b64 v[64:65], v14 offset:0
    ds_read_b64 v[66:67], v14 offset:8
    ds_read_b128 v[68:71], v20 offset:192
    ds_read_b128 v[72:75], v20 offset:704
    ds_read_b64 v[76:77], v14 offset:512
    ds_read_b64 v[78:79], v14 offset:520
    ds_read_b128 v[80:83], v20 offset:1216
    ds_read_b64 v[84:85], v14 offset:1024
    ds_read_b64 v[86:87], v14 offset:1032
    ds_read_b128 v[88:91], v20 offset:1728
    ds_read_b64 v[92:93], v14 offset:1536
    ds_read_b64 v[94:95], v14 offset:1544
    s_waitcnt lgkmcnt(9)
    v_mfma_f32_16x16x32_bf16 v[32:35], v[64:67], v[68:71], 0
    ds_read_b128 v[96:99], v20 offset:2240
    ds_read_b64 v[100:101], v14 offset:2048
    ds_read_b64 v[102:103], v14 offset:2056
    s_waitcnt lgkmcnt(11)
    v_mfma_f32_16x16x32_bf16 v[36:39], v[64:67], v[72:75], 0
    ds_read_b128 v[104:107], v20 offset:2752
    s_waitcnt lgkmcnt(10)
    v_mfma_f32_16x16x32_bf16 v[36:39], v[76:79], v[68:71], v[36:39]
    ds_read_b64 v[108:109], v14 offset:2560
    ds_read_b64 v[110:111], v14 offset:2568
    v_mfma_f32_16x16x32_bf16 v[40:43], v[76:79], v[72:75], 0
    s_waitcnt lgkmcnt(11)
    v_mfma_f32_16x16x32_bf16 v[40:43], v[64:67], v[80:83], v[40:43]
    ds_read_b128 v[112:115], v20 offset:3264
    s_waitcnt lgkmcnt(10)
    v_mfma_f32_16x16x32_bf16 v[40:43], v[84:87], v[68:71], v[40:43]
    ds_read_b64 v[116:117], v14 offset:3072
    ds_read_b64 v[118:119], v14 offset:3080
    v_mfma_f32_16x16x32_bf16 v[44:47], v[76:79], v[80:83], 0
    v_mfma_f32_16x16x32_bf16 v[44:47], v[84:87], v[72:75], v[44:47]
    v_mfma_f32_16x16x32_bf16 v[48:51], v[84:87], v[80:83], 0
    s_waitcnt lgkmcnt(5)
    v_mfma_f32_16x16x32_bf16 v[44:47], v[64:67], v[88:91], v[44:47]
    ds_read_b128 v[120:123], v20 offset:3776
    v_mfma_f32_16x16x32_bf16 v[44:47], v[92:95], v[68:71], v[44:47]
    ds_read_b64 v[124:125], v14 offset:3584
    ds_read_b64 v[126:127], v14 offset:3592
    v_mfma_f32_16x16x32_bf16 v[48:51], v[76:79], v[88:91], v[48:51]
    ds_read_b64 v[128:129], v14 offset:64
    ds_read_b64 v[130:131], v14 offset:72
    v_mfma_f32_16x16x32_bf16 v[48:51], v[92:95], v[72:75], v[48:51]
    ds_read_b128 v[132:135], v20 offset:128
    v_mfma_f32_16x16x32_bf16 v[52:55], v[84:87], v[88:91], 0
    ds_read_b128 v[136:139], v20 offset:640
    v_mfma_f32_16x16x32_bf16 v[52:55], v[92:95], v[80:83], v[52:55]
    v_mfma_f32_16x16x32_bf16 v[56:59], v[92:95], v[88:91], 0
    v_mfma_f32_16x16x32_bf16 v[48:51], v[64:67], v[96:99], v[48:51]
    v_mfma_f32_16x16x32_bf16 v[48:51], v[100:103], v[68:71], v[48:51]
    v_mfma_f32_16x16x32_bf16 v[52:55], v[76:79], v[96:99], v[52:55]
    v_mfma_f32_16x16x32_bf16 v[52:55], v[100:103], v[72:75], v[52:55]
    v_mfma_f32_16x16x32_bf16 v[56:59], v[84:87], v[96:99], v[56:59]
    v_mfma_f32_16x16x32_bf16 v[56:59], v[100:103], v[80:83], v[56:59]
    v_mfma_f32_16x16x32_bf16 v[60:63], v[92:95], v[96:99], 0
    v_mfma_f32_16x16x32_bf16 v[60:63], v[100:103], v[88:91], v[60:63]
    v_mfma_f32_16x16x32_bf16 v[52:55], v[64:67], v[104:107], v[52:55]
    s_waitcnt lgkmcnt(0)
    v_mfma_f32_16x16x32_bf16 v[52:55], v[108:111], v[68:71], v[52:55]
    ds_read_b64 v[140:141], v14 offset:576
    ds_read_b64 v[142:143], v14 offset:584
    v_mfma_f32_16x16x32_bf16 v[56:59], v[76:79], v[104:107], v[56:59]
    ds_read_b128 v[144:147], v20 offset:1152
    v_mfma_f32_16x16x32_bf16 v[56:59], v[108:111], v[72:75], v[56:59]
    ds_read_b64 v[148:149], v14 offset:1088
    ds_read_b64 v[150:151], v14 offset:1096
    v_mfma_f32_16x16x32_bf16 v[60:63], v[84:87], v[104:107], v[60:63]
    ds_read_b128 v[152:155], v20 offset:1664
    v_mfma_f32_16x16x32_bf16 v[60:63], v[108:111], v[80:83], v[60:63]
    ds_read_b64 v[156:157], v14 offset:1600
    ds_read_b64 v[158:159], v14 offset:1608
    v_mfma_f32_16x16x32_bf16 v[56:59], v[64:67], v[112:115], v[56:59]
    ds_read_b128 v[160:163], v20 offset:2176
    v_mfma_f32_16x16x32_bf16 v[56:59], v[116:119], v[68:71], v[56:59]
    ds_read_b64 v[164:165], v14 offset:2112
    ds_read_b64 v[166:167], v14 offset:2120
    v_mfma_f32_16x16x32_bf16 v[60:63], v[76:79], v[112:115], v[60:63]
    ds_read_b128 v[168:171], v20 offset:2688
    v_mfma_f32_16x16x32_bf16 v[60:63], v[116:119], v[72:75], v[60:63]
    v_mfma_f32_16x16x32_bf16 v[60:63], v[64:67], v[120:123], v[60:63]
    v_mfma_f32_16x16x32_bf16 v[60:63], v[124:127], v[68:71], v[60:63]
    v_mfma_f32_16x16x32_bf16 v[32:35], v[128:131], v[132:135], v[32:35]
    v_mfma_f32_16x16x32_bf16 v[36:39], v[128:131], v[136:139], v[36:39]
    s_waitcnt lgkmcnt(3)
    v_mfma_f32_16x16x32_bf16 v[36:39], v[140:143], v[132:135], v[36:39]
    ds_read_b64 v[172:173], v14 offset:2624
    ds_read_b64 v[174:175], v14 offset:2632
    v_mfma_f32_16x16x32_bf16 v[40:43], v[140:143], v[136:139], v[40:43]
    ds_read_b128 v[176:179], v20 offset:3200
    v_mfma_f32_16x16x32_bf16 v[40:43], v[128:131], v[144:147], v[40:43]
    ds_read_b64 v[180:181], v14 offset:3136
    ds_read_b64 v[182:183], v14 offset:3144
    v_mfma_f32_16x16x32_bf16 v[40:43], v[148:151], v[132:135], v[40:43]
    ds_read_b128 v[184:187], v20 offset:3712
    v_mfma_f32_16x16x32_bf16 v[44:47], v[140:143], v[144:147], v[44:47]
    ds_read_b64 v[188:189], v14 offset:3648
    ds_read_b64 v[190:191], v14 offset:3656
    v_mfma_f32_16x16x32_bf16 v[44:47], v[148:151], v[136:139], v[44:47]
    ds_read_b64 v[192:193], v14 offset:128
    ds_read_b64 v[194:195], v14 offset:136
    v_mfma_f32_16x16x32_bf16 v[48:51], v[148:151], v[144:147], v[48:51]
    v_mfma_f32_16x16x32_bf16 v[44:47], v[128:131], v[152:155], v[44:47]
    v_mfma_f32_16x16x32_bf16 v[44:47], v[156:159], v[132:135], v[44:47]
    v_mfma_f32_16x16x32_bf16 v[48:51], v[140:143], v[152:155], v[48:51]
    v_mfma_f32_16x16x32_bf16 v[48:51], v[156:159], v[136:139], v[48:51]
    v_mfma_f32_16x16x32_bf16 v[52:55], v[148:151], v[152:155], v[52:55]
    v_mfma_f32_16x16x32_bf16 v[52:55], v[156:159], v[144:147], v[52:55]
    v_mfma_f32_16x16x32_bf16 v[56:59], v[156:159], v[152:155], v[56:59]
    v_mfma_f32_16x16x32_bf16 v[48:51], v[128:131], v[160:163], v[48:51]
    s_waitcnt lgkmcnt(0)
    v_mfma_f32_16x16x32_bf16 v[48:51], v[164:167], v[132:135], v[48:51]
    ds_read_b128 v[196:199], v20 offset:64
    v_mfma_f32_16x16x32_bf16 v[52:55], v[140:143], v[160:163], v[52:55]
    ds_read_b128 v[200:203], v20 offset:576
    v_mfma_f32_16x16x32_bf16 v[52:55], v[164:167], v[136:139], v[52:55]
    ds_read_b64 v[204:205], v14 offset:640
    ds_read_b64 v[206:207], v14 offset:648
    v_mfma_f32_16x16x32_bf16 v[56:59], v[148:151], v[160:163], v[56:59]
    ds_read_b128 v[208:211], v20 offset:1088
    v_mfma_f32_16x16x32_bf16 v[56:59], v[164:167], v[144:147], v[56:59]
    ds_read_b64 v[212:213], v14 offset:1152
    ds_read_b64 v[214:215], v14 offset:1160
    v_mfma_f32_16x16x32_bf16 v[60:63], v[156:159], v[160:163], v[60:63]
    ds_read_b128 v[216:219], v20 offset:1600
    v_mfma_f32_16x16x32_bf16 v[60:63], v[164:167], v[152:155], v[60:63]
    ds_read_b64 v[220:221], v14 offset:1664
    ds_read_b64 v[222:223], v14 offset:1672
    v_mfma_f32_16x16x32_bf16 v[52:55], v[128:131], v[168:171], v[52:55]
    ds_read_b128 v[92:95], v20 offset:2112
    v_mfma_f32_16x16x32_bf16 v[52:55], v[172:175], v[132:135], v[52:55]
    ds_read_b64 v[96:97], v14 offset:2176
    ds_read_b64 v[98:99], v14 offset:2184
    v_mfma_f32_16x16x32_bf16 v[56:59], v[140:143], v[168:171], v[56:59]
    v_mfma_f32_16x16x32_bf16 v[56:59], v[172:175], v[136:139], v[56:59]
    v_mfma_f32_16x16x32_bf16 v[60:63], v[148:151], v[168:171], v[60:63]
    v_mfma_f32_16x16x32_bf16 v[60:63], v[172:175], v[144:147], v[60:63]
    v_mfma_f32_16x16x32_bf16 v[56:59], v[128:131], v[176:179], v[56:59]
    v_mfma_f32_16x16x32_bf16 v[56:59], v[180:183], v[132:135], v[56:59]
    v_mfma_f32_16x16x32_bf16 v[60:63], v[140:143], v[176:179], v[60:63]
    v_mfma_f32_16x16x32_bf16 v[60:63], v[180:183], v[136:139], v[60:63]
    v_mfma_f32_16x16x32_bf16 v[60:63], v[128:131], v[184:187], v[60:63]
    v_mfma_f32_16x16x32_bf16 v[60:63], v[188:191], v[132:135], v[60:63]
    s_waitcnt lgkmcnt(0)
    v_mfma_f32_16x16x32_bf16 v[32:35], v[192:195], v[196:199], v[32:35]
    ds_read_b128 v[100:103], v20 offset:2624
    v_mfma_f32_16x16x32_bf16 v[36:39], v[192:195], v[200:203], v[36:39]
    ds_read_b64 v[88:89], v14 offset:2688
    ds_read_b64 v[90:91], v14 offset:2696
    v_mfma_f32_16x16x32_bf16 v[36:39], v[204:207], v[196:199], v[36:39]
    ds_read_b128 v[84:87], v20 offset:3136
    v_mfma_f32_16x16x32_bf16 v[40:43], v[204:207], v[200:203], v[40:43]
    ds_read_b64 v[104:105], v14 offset:3200
    ds_read_b64 v[106:107], v14 offset:3208
    v_mfma_f32_16x16x32_bf16 v[40:43], v[192:195], v[208:211], v[40:43]
    ds_read_b128 v[108:111], v20 offset:3648
    v_mfma_f32_16x16x32_bf16 v[40:43], v[212:215], v[196:199], v[40:43]
    ds_read_b64 v[80:81], v14 offset:3712
    ds_read_b64 v[82:83], v14 offset:3720
    v_mfma_f32_16x16x32_bf16 v[44:47], v[204:207], v[208:211], v[44:47]
    ds_read_b64 v[76:77], v14 offset:192
    ds_read_b64 v[78:79], v14 offset:200
    v_mfma_f32_16x16x32_bf16 v[44:47], v[212:215], v[200:203], v[44:47]
    ds_read_b128 v[112:115], v20 offset:0
    v_mfma_f32_16x16x32_bf16 v[48:51], v[212:215], v[208:211], v[48:51]
    v_mfma_f32_16x16x32_bf16 v[44:47], v[192:195], v[216:219], v[44:47]
    v_mfma_f32_16x16x32_bf16 v[44:47], v[220:223], v[196:199], v[44:47]
    v_mfma_f32_16x16x32_bf16 v[48:51], v[204:207], v[216:219], v[48:51]
    v_mfma_f32_16x16x32_bf16 v[48:51], v[220:223], v[200:203], v[48:51]
    v_mfma_f32_16x16x32_bf16 v[52:55], v[212:215], v[216:219], v[52:55]
    v_mfma_f32_16x16x32_bf16 v[52:55], v[220:223], v[208:211], v[52:55]
    v_mfma_f32_16x16x32_bf16 v[56:59], v[220:223], v[216:219], v[56:59]
    v_mfma_f32_16x16x32_bf16 v[48:51], v[192:195], v[92:95], v[48:51]
    v_mfma_f32_16x16x32_bf16 v[48:51], v[96:99], v[196:199], v[48:51]
    v_mfma_f32_16x16x32_bf16 v[52:55], v[204:207], v[92:95], v[52:55]
    v_mfma_f32_16x16x32_bf16 v[52:55], v[96:99], v[200:203], v[52:55]
    v_mfma_f32_16x16x32_bf16 v[56:59], v[212:215], v[92:95], v[56:59]
    v_mfma_f32_16x16x32_bf16 v[56:59], v[96:99], v[208:211], v[56:59]
    v_mfma_f32_16x16x32_bf16 v[60:63], v[220:223], v[92:95], v[60:63]
    v_mfma_f32_16x16x32_bf16 v[60:63], v[96:99], v[216:219], v[60:63]
    s_waitcnt lgkmcnt(0)
    v_mfma_f32_16x16x32_bf16 v[52:55], v[192:195], v[100:103], v[52:55]
    ds_read_b128 v[116:119], v20 offset:512
    v_mfma_f32_16x16x32_bf16 v[52:55], v[88:91], v[196:199], v[52:55]
    ds_read_b64 v[72:73], v14 offset:704
    ds_read_b64 v[74:75], v14 offset:712
    v_mfma_f32_16x16x32_bf16 v[56:59], v[204:207], v[100:103], v[56:59]
    ds_read_b128 v[64:67], v20 offset:1024
    v_mfma_f32_16x16x32_bf16 v[56:59], v[88:91], v[200:203], v[56:59]
    ds_read_b64 v[120:121], v14 offset:1216
    ds_read_b64 v[122:123], v14 offset:1224
    v_mfma_f32_16x16x32_bf16 v[60:63], v[212:215], v[100:103], v[60:63]
    ds_read_b128 v[124:127], v20 offset:1536
    v_mfma_f32_16x16x32_bf16 v[60:63], v[88:91], v[208:211], v[60:63]
    ds_read_b64 v[68:69], v14 offset:1728
    ds_read_b64 v[70:71], v14 offset:1736
    v_mfma_f32_16x16x32_bf16 v[56:59], v[192:195], v[84:87], v[56:59]
    ds_read_b128 v[156:159], v20 offset:2048
    v_mfma_f32_16x16x32_bf16 v[56:59], v[104:107], v[196:199], v[56:59]
    ds_read_b64 v[160:161], v14 offset:2240
    ds_read_b64 v[162:163], v14 offset:2248
    v_mfma_f32_16x16x32_bf16 v[60:63], v[204:207], v[84:87], v[60:63]
    v_mfma_f32_16x16x32_bf16 v[60:63], v[104:107], v[200:203], v[60:63]
    v_mfma_f32_16x16x32_bf16 v[60:63], v[192:195], v[108:111], v[60:63]
    v_mfma_f32_16x16x32_bf16 v[60:63], v[80:83], v[196:199], v[60:63]
    v_mfma_f32_16x16x32_bf16 v[32:35], v[76:79], v[112:115], v[32:35]
    s_waitcnt lgkmcnt(3)
    v_mfma_f32_16x16x32_bf16 v[36:39], v[76:79], v[116:119], v[36:39]
    ds_read_b128 v[164:167], v20 offset:2560
    v_mfma_f32_16x16x32_bf16 v[36:39], v[72:75], v[112:115], v[36:39]
    ds_read_b64 v[152:153], v14 offset:2752
    ds_read_b64 v[154:155], v14 offset:2760
    v_mfma_f32_16x16x32_bf16 v[40:43], v[72:75], v[116:119], v[40:43]
    ds_read_b128 v[148:151], v20 offset:3072
    v_mfma_f32_16x16x32_bf16 v[40:43], v[76:79], v[64:67], v[40:43]
    ds_read_b64 v[168:169], v14 offset:3264
    ds_read_b64 v[170:171], v14 offset:3272
    v_mfma_f32_16x16x32_bf16 v[40:43], v[120:123], v[112:115], v[40:43]
    ds_read_b128 v[172:175], v20 offset:3584
    v_mfma_f32_16x16x32_bf16 v[44:47], v[72:75], v[64:67], v[44:47]
    ds_read_b64 v[144:145], v14 offset:3776
    ds_read_b64 v[146:147], v14 offset:3784
    v_mfma_f32_16x16x32_bf16 v[44:47], v[120:123], v[116:119], v[44:47]
    v_mfma_f32_16x16x32_bf16 v[48:51], v[120:123], v[64:67], v[48:51]
    ds_write_b128 v24, v[32:35] offset:0
    v_mfma_f32_16x16x32_bf16 v[44:47], v[76:79], v[124:127], v[44:47]
    v_mfma_f32_16x16x32_bf16 v[44:47], v[68:71], v[112:115], v[44:47]
    ds_write_b128 v24, v[36:39] offset:1024
    v_mfma_f32_16x16x32_bf16 v[48:51], v[72:75], v[124:127], v[48:51]
    v_mfma_f32_16x16x32_bf16 v[48:51], v[68:71], v[116:119], v[48:51]
    v_mfma_f32_16x16x32_bf16 v[52:55], v[120:123], v[124:127], v[52:55]
    ds_write_b128 v24, v[40:43] offset:2048
    v_mfma_f32_16x16x32_bf16 v[52:55], v[68:71], v[64:67], v[52:55]
    v_mfma_f32_16x16x32_bf16 v[56:59], v[68:71], v[124:127], v[56:59]
    s_waitcnt lgkmcnt(3)
    v_mfma_f32_16x16x32_bf16 v[48:51], v[76:79], v[156:159], v[48:51]
    v_mfma_f32_16x16x32_bf16 v[48:51], v[160:163], v[112:115], v[48:51]
    v_mfma_f32_16x16x32_bf16 v[52:55], v[72:75], v[156:159], v[52:55]
    ds_write_b128 v24, v[44:47] offset:3072
    v_mfma_f32_16x16x32_bf16 v[52:55], v[160:163], v[116:119], v[52:55]
    v_mfma_f32_16x16x32_bf16 v[56:59], v[120:123], v[156:159], v[56:59]
    v_mfma_f32_16x16x32_bf16 v[56:59], v[160:163], v[64:67], v[56:59]
    v_mfma_f32_16x16x32_bf16 v[60:63], v[68:71], v[156:159], v[60:63]
    v_mfma_f32_16x16x32_bf16 v[60:63], v[160:163], v[124:127], v[60:63]
    v_mfma_f32_16x16x32_bf16 v[52:55], v[76:79], v[164:167], v[52:55]
    v_mfma_f32_16x16x32_bf16 v[52:55], v[152:155], v[112:115], v[52:55]
    ds_write_b128 v24, v[48:51] offset:4096
    v_mfma_f32_16x16x32_bf16 v[56:59], v[72:75], v[164:167], v[56:59]
    v_mfma_f32_16x16x32_bf16 v[56:59], v[152:155], v[116:119], v[56:59]
    v_mfma_f32_16x16x32_bf16 v[60:63], v[120:123], v[164:167], v[60:63]
    v_mfma_f32_16x16x32_bf16 v[60:63], v[152:155], v[64:67], v[60:63]
    v_mfma_f32_16x16x32_bf16 v[56:59], v[76:79], v[148:151], v[56:59]
    v_mfma_f32_16x16x32_bf16 v[56:59], v[168:171], v[112:115], v[56:59]
    v_mfma_f32_16x16x32_bf16 v[60:63], v[72:75], v[148:151], v[60:63]
    v_mfma_f32_16x16x32_bf16 v[60:63], v[168:171], v[116:119], v[60:63]
    ds_write_b128 v24, v[52:55] offset:5120
    v_mfma_f32_16x16x32_bf16 v[60:63], v[76:79], v[172:175], v[60:63]
    v_mfma_f32_16x16x32_bf16 v[60:63], v[144:147], v[112:115], v[60:63]
    s_nop 7
    ds_write_b128 v24, v[56:59] offset:6144
    ds_write_b128 v24, v[60:63] offset:7168
    s_waitcnt lgkmcnt(0)
    ds_write_b32 v21, v19
    s_setprio 0
    s_cmp_ge_u32 s53, 28
    s_cbranch_scc1 END
    s_mov_b32 s36, s4
    s_and_b32 s37, s5, 0xffff
    s_mov_b32 s38, 1605632
    s_mov_b32 s39, 0x20000
    s_mov_b32 s40, s8
    s_and_b32 s41, s9, 0xffff
    s_mov_b32 s42, 1605632
    s_mov_b32 s43, 0x20000
    s_mov_b32 s48, s64
    s_and_b32 s49, s65, 0xffff
    s_mov_b32 s50, 1835008
    s_mov_b32 s51, 0x20000
    v_lshrrev_b32 v5, 2, v1
    v_mul_u32_u24 v5, 3584, v5
    v_and_b32 v7, 3, v1
    v_lshl_add_u32 v3, v7, 4, v5
    s_lshl_b32 s58, s68, 6
    v_add_u32 v3, s58, v3
    v_bfe_u32 v5, v1, 2, 2
    v_lshrrev_b32 v12, 5, v1
    v_lshl_add_u32 v12, v12, 2, v5
    v_lshlrev_b32 v12, 6, v12
    v_bfe_u32 v5, v1, 4, 1
    v_lshl_add_u32 v12, v5, 5, v12
    v_lshl_add_u32 v12, v7, 3, v12
    s_xor_b32 s58, s54, 4
    s_mul_i32 s58, s58, 7168
    s_add_u32 s66, s58, 99840
    v_add_u32 v12, s66, v12
    s_mov_b32 s15, 0x3f803f80
    v_xor_b32 v22, 4, v21
    v_mov_b32 v21, 161312
    s_bfe_u32 s58, s54, 0x10001
    s_mul_i32 s58, s58, 16640
    s_and_b32 s59, s54, 1
    s_lshl_b32 s59, s59, 13
    s_add_u32 s59, s59, s58
    s_sub_u32 s58, s59, s66
    v_add_u32 v13, s58, v12
    s_mov_b32 s60, 0
SPIN_1:
    ds_read_b32 v15, v22
    s_waitcnt lgkmcnt(0)
    v_cmp_ne_u32 vcc, v15, v19
    s_cbranch_vccz SPIND_2
    s_sleep 1
    s_add_u32 s60, s60, 1
    s_cmp_lt_u32 s60, 1600000
    s_cbranch_scc1 SPIN_1
SPIND_2:
    s_add_u32 s60, s69, 1
    s_and_b32 s60, s60, 3
    s_mul_i32 s4, s60, 401408
    s_add_u32 s60, s69, 2
    s_and_b32 s60, s60, 3
    s_mul_i32 s5, s60, 401408
    s_add_u32 s60, s69, 3
    s_and_b32 s60, s60, 3
    s_mul_i32 s6, s60, 401408
    v_add_u32 v26, 56320, v3
    v_add_u32 v27, 112640, v3
    v_add_u32 v28, 168960, v3
    s_add_u32 m0, s59, 0
    s_add_u32 s67, s4, 0
    buffer_load_dwordx4 v3, s[36:39], s67 offen offset:0 lds
    buffer_load_dwordx4 v26, s[36:39], s67 offen offset:1024 lds
    buffer_load_dwordx4 v27, s[36:39], s67 offen offset:2048 lds
    buffer_load_dwordx4 v28, s[36:39], s67 offen offset:3072 lds
    s_add_u32 m0, s59, 4096
    s_add_u32 s67, s4, 229376
    buffer_load_dwordx4 v3, s[36:39], s67 offen offset:0 lds
    buffer_load_dwordx4 v26, s[36:39], s67 offen offset:1024 lds
    buffer_load_dwordx4 v27, s[36:39], s67 offen offset:2048 lds
    s_add_u32 m0, s59, 7168
    s_add_u32 s67, s5, 0
    buffer_load_dwordx4 v3, s[36:39], s67 offen offset:0 lds
    v_lshrrev_b32 v4, 3, v1
    v_mul_u32_u24 v4, 896, v4
    v_and_b32 v5, 7, v1
    v_lshlrev_b32 v5, 4, v5
    v_bfe_u32 v24, v1, 4, 1
    v_lshlrev_b32 v24, 6, v24
    v_xor_b32 v5, v5, v24
    v_add_u32 v24, v4, v5
    v_lshrrev_b32 v4, 3, v1
    v_mul_u32_u24 v4, 128, v4
    v_and_b32 v5, 7, v1
    v_lshlrev_b32 v5, 4, v5
    v_bfe_u32 v14, v1, 4, 1
    v_lshlrev_b32 v14, 6, v14
    v_xor_b32 v5, v5, v14
    v_add_u32 v14, v4, v5
    v_and_b32 v6, 3, v1
    v_bfe_u32 v7, v1, 2, 2
    v_lshrrev_b32 v8, 5, v1
    v_lshl_add_u32 v8, v8, 2, v7
    v_lshlrev_b32 v4, 7, v8
    v_lshrrev_b32 v7, 1, v7
    v_lshlrev_b32 v7, 6, v7
    v_add_u32 v4, v4, v7
    v_bfe_u32 v7, v1, 4, 1
    v_lshl_add_u32 v4, v7, 5, v4
    v_lshl_add_u32 v4, v6, 3, v4
    v_xor_b32 v5, 64, v4
    s_add_u32 s60, s69, 1
    s_and_b32 s60, s60, 3
    s_cselect_b32 s60, 1, -3
    s_mul_i32 s8, s60, 14336
    s_add_u32 s60, s69, 2
    s_and_b32 s60, s60, 3
    s_cselect_b32 s60, 1, -3
    s_mul_i32 s9, s60, 14336
    s_add_u32 s60, s69, 3
    s_and_b32 s60, s60, 3
    s_cselect_b32 s60, 1, -3
    s_mul_i32 s10, s60, 14336
    s_mul_i32 s58, s54, 7168
    v_add_u32 v9, s58, v4
    v_add_u32 v10, s58, v5
    s_mul_i32 s58, s54, 12288
    s_add_u32 s58, s58, 57344
    v_add_u32 v7, s58, v4
    v_add_u32 v8, s58, v5
    s_mul_i32 s60, s69, 14336
    v_add_u32 v4, s60, v4
    v_add_u32 v5, s60, v5
    v_mov_b32 v23, 0
    s_mov_b32 s60, 0
SPIN_3:
    ds_read_b32 v15, v21
    s_waitcnt lgkmcnt(0)
    v_cmp_ne_u32 vcc, v15, v19
    s_cbranch_vccz SPIND_4
    s_sleep 1
    s_add_u32 s60, s60, 1
    s_cmp_lt_u32 s60, 1600000
    s_cbranch_scc1 SPIN_3
SPIND_4:
    ds_read_b64_tr_b16 v[144:145], v12 offset:0
    ds_read_b64_tr_b16 v[146:147], v12 offset:512
    ds_read_b64_tr_b16 v[148:149], v12 offset:1024
    ds_read_b64_tr_b16 v[150:151], v12 offset:1536
    ds_read_b64_tr_b16 v[152:153], v12 offset:2048
    ds_read_b64_tr_b16 v[154:155], v12 offset:2560
    ds_read_b64_tr_b16 v[156:157], v12 offset:3072
    ds_read_b64_tr_b16 v[158:159], v12 offset:3584
    ds_read_b64_tr_b16 v[160:161], v12 offset:4096
    ds_read_b64_tr_b16 v[162:163], v12 offset:4608
    ds_read_b64_tr_b16 v[164:165], v12 offset:5120
    ds_read_b64_tr_b16 v[166:167], v12 offset:5632
    ds_read_b64_tr_b16 v[168:169], v12 offset:6144
    ds_read_b64_tr_b16 v[170:171], v12 offset:6656
    s_waitcnt lgkmcnt(6)
    s_add_u32 m0, s66, 0
    s_add_u32 s67, s5, 57344
    buffer_load_dwordx4 v3, s[36:39], s67 offen offset:0 lds
    buffer_load_dwordx4 v26, s[36:39], s67 offen offset:1024 lds
    buffer_load_dwordx4 v27, s[36:39], s67 offen offset:2048 lds
    buffer_load_dwordx4 v28, s[36:39], s67 offen offset:3072 lds
    s_waitcnt lgkmcnt(0)
    s_add_u32 m0, s66, 4096
    s_add_u32 s67, s5, 286720
    buffer_load_dwordx4 v3, s[36:39], s67 offen offset:0 lds
    buffer_load_dwordx4 v26, s[36:39], s67 offen offset:1024 lds
    s_add_u32 m0, s66, 6144
    s_add_u32 s67, s6, 0
    buffer_load_dwordx4 v3, s[36:39], s67 offen offset:0 lds
    s_waitcnt vmcnt(11)
    ds_read_b64_tr_b16 v[172:173], v13 offset:0
    ds_read_b64_tr_b16 v[174:175], v13 offset:512
    ds_read_b64_tr_b16 v[176:177], v13 offset:1024
    ds_read_b64_tr_b16 v[178:179], v13 offset:1536
    ds_read_b64_tr_b16 v[180:181], v13 offset:2048
    ds_read_b64_tr_b16 v[182:183], v13 offset:2560
    ds_read_b64_tr_b16 v[184:185], v13 offset:3072
    ds_read_b64_tr_b16 v[186:187], v13 offset:3584
    s_waitcnt vmcnt(7)
    ds_read_b64_tr_b16 v[188:189], v13 offset:4096
    ds_read_b64_tr_b16 v[190:191], v13 offset:4608
    ds_read_b64_tr_b16 v[192:193], v13 offset:5120
    ds_read_b64_tr_b16 v[194:195], v13 offset:5632
    ds_read_b64_tr_b16 v[196:197], v13 offset:6144
    ds_read_b64_tr_b16 v[198:199], v13 offset:6656
    ds_read_b64_tr_b16 v[200:201], v13 offset:7168
    s_waitcnt lgkmcnt(14)
    ds_read_b64_tr_b16 v[202:203], v13 offset:7680
    s_waitcnt vmcnt(4)
    s_waitcnt lgkmcnt(14)
    ds_read_b64_tr_b16 v[204:205], v12 offset:0
    s_waitcnt lgkmcnt(14)
    ds_read_b64_tr_b16 v[206:207], v12 offset:512
    s_waitcnt lgkmcnt(14)
    ds_read_b64_tr_b16 v[208:209], v12 offset:1024
    s_waitcnt lgkmcnt(14)
    ds_read_b64_tr_b16 v[210:211], v12 offset:1536
    s_waitcnt lgkmcnt(14)
    ds_read_b64_tr_b16 v[212:213], v12 offset:2048
    s_waitcnt lgkmcnt(14)
    ds_read_b64_tr_b16 v[214:215], v12 offset:2560
    s_waitcnt lgkmcnt(0)
    s_add_u32 m0, s66, 0
    s_add_u32 s67, s6, 57344
    buffer_load_dwordx4 v3, s[36:39], s67 offen offset:0 lds
    buffer_load_dwordx4 v26, s[36:39], s67 offen offset:1024 lds
    buffer_load_dwordx4 v27, s[36:39], s67 offen offset:2048 lds
    s_waitcnt vmcnt(4)
    ds_read_b64_tr_b16 v[216:217], v12 offset:3072
    ds_read_b64_tr_b16 v[218:219], v12 offset:3584
    ds_read_b64_tr_b16 v[220:221], v12 offset:4096
    ds_read_b64_tr_b16 v[222:223], v12 offset:4608
    ds_read_b64_tr_b16 v[224:225], v12 offset:5120
    ds_read_b64_tr_b16 v[226:227], v12 offset:5632
    s_waitcnt lgkmcnt(0)
    s_add_u32 m0, s66, 3072
    s_add_u32 s67, s6, 229376
    buffer_load_dwordx4 v3, s[36:39], s67 offen offset:0 lds
    buffer_load_dwordx4 v26, s[36:39], s67 offen offset:1024 lds
    buffer_load_dwordx4 v27, s[36:39], s67 offen offset:2048 lds
    s_branch RING_J
SET_HI:
    v_and_b32 v22, 31, v1
    v_lshlrev_b32 v22, 2, v22
    s_cmp_lg_u32 s54, 7
    s_cbranch_scc1 H1_W
    s_mov_b32 s60, 0
H1_P:
    buffer_load_dword v15, v22, s[28:31], s61 offen sc1
    s_waitcnt vmcnt(0)
    v_cmp_ne_u32 vcc, s32, v15
    s_cbranch_vccz H1_W
    s_add_u32 s60, s60, 1
    s_cmp_lt_u32 s60, 24
    s_cbranch_scc1 H1_P
    v_mov_b32 v15, 161328
    ds_write_b32 v15, v19
H1_W:
    v_mov_b32 v21, 161328
    s_and_b32 s60, s54, 3
    s_lshl_b32 s59, s60, 11
    s_lshl_b32 s62, s55, 14
    s_add_u32 s62, s62, s59
    s_add_u32 s62, s62, 8192
    s_waitcnt lgkmcnt(0)
    s_barrier
    buffer_load_dwordx4 v2, s[28:31], s2 offen sc1 lds
    ds_read_b32 v15, v21
    s_waitcnt lgkmcnt(0)
    v_cmp_ne_u32 vcc, 0, v15
    s_cbranch_vccnz SLOW1
HI_BACK:
    s_add_u32 m0, s59, 42496
    s_and_b32 s60, s54, 3
    buffer_load_dwordx4 v2, s[28:31], s62 offen sc1 lds
    buffer_load_dwordx4 v2, s[28:31], s62 offen offset:1024 sc1 lds
    s_lshl_b32 s2, s60, 13
    s_add_u32 s61, s2, 13631488
    s_add_u32 s62, s61, 4096
    s_waitcnt vmcnt(2)
    s_barrier
    buffer_load_dwordx4 v[32:35], v2, s[28:31], s61 offen offset:0 sc1
    buffer_load_dwordx4 v[36:39], v2, s[28:31], s61 offen offset:1024 sc1
    buffer_load_dwordx4 v[40:43], v2, s[28:31], s61 offen offset:2048 sc1
    buffer_load_dwordx4 v[44:47], v2, s[28:31], s61 offen offset:3072 sc1
    buffer_load_dwordx4 v[48:51], v2, s[28:31], s62 offen offset:0 sc1
    buffer_load_dwordx4 v[52:55], v2, s[28:31], s62 offen offset:1024 sc1
    buffer_load_dwordx4 v[56:59], v2, s[28:31], s62 offen offset:2048 sc1
    buffer_load_dwordx4 v[60:63], v2, s[28:31], s62 offen offset:3072 sc1
    s_mov_b32 s36, s4
    s_and_b32 s37, s5, 0xffff
    s_mov_b32 s38, 1605632
    s_mov_b32 s39, 0x20000
    s_mov_b32 s40, s8
    s_and_b32 s41, s9, 0xffff
    s_mov_b32 s42, 1605632
    s_mov_b32 s43, 0x20000
    s_mov_b32 s48, s64
    s_and_b32 s49, s65, 0xffff
    s_mov_b32 s50, 1835008
    s_mov_b32 s51, 0x20000
    v_lshrrev_b32 v5, 2, v1
    v_mul_u32_u24 v5, 3584, v5
    v_and_b32 v7, 3, v1
    v_lshl_add_u32 v3, v7, 4, v5
    s_lshl_b32 s58, s68, 6
    v_add_u32 v3, s58, v3
    v_bfe_u32 v5, v1, 2, 2
    v_lshrrev_b32 v12, 5, v1
    v_lshl_add_u32 v12, v12, 2, v5
    v_lshlrev_b32 v12, 6, v12
    v_bfe_u32 v5, v1, 4, 1
    v_lshl_add_u32 v12, v5, 5, v12
    v_lshl_add_u32 v12, v7, 3, v12
    s_xor_b32 s58, s54, 4
    s_mul_i32 s58, s58, 7168
    s_add_u32 s66, s58, 99840
    v_add_u32 v12, s66, v12
    s_mov_b32 s15, 0x3f803f80
    s_mov_b32 s60, 0
    s_cmp_ge_u32 s53, 28
    s_cbranch_scc1 S_W0
    v_add_u32 v4, -256, v3
    s_xor_b32 s62, s69, 2
    s_mul_i32 s62, s62, 401408
    s_add_u32 m0, s66, 28672
    s_nop 0
    buffer_load_dwordx4 v4, s[36:39], s62 offen lds
    s_add_u32 s62, s62, 57344
    s_add_u32 m0, s66, 29696
    s_nop 0
    buffer_load_dwordx4 v4, s[36:39], s62 offen lds
    s_add_u32 s62, s62, 57344
    s_add_u32 m0, s66, 30720
    s_nop 0
    buffer_load_dwordx4 v4, s[36:39], s62 offen lds
    s_add_u32 s62, s62, 57344
    s_add_u32 m0, s66, 31744
    s_nop 0
    buffer_load_dwordx4 v4, s[36:39], s62 offen lds
    s_add_u32 s62, s62, 57344
    s_add_u32 m0, s66, 32768
    s_nop 0
    buffer_load_dwordx4 v4, s[36:39], s62 offen lds
    s_add_u32 s62, s62, 57344
    s_add_u32 m0, s66, 33792
    s_nop 0
    buffer_load_dwordx4 v4, s[36:39], s62 offen lds
    s_add_u32 s62, s62, 57344
    s_add_u32 m0, s66, 34816
    s_nop 0
    buffer_load_dwordx4 v4, s[36:39], s62 offen lds
    s_add_u32 s62, s62, 57344
    s_waitcnt vmcnt(7)
    s_branch S_CHK
S_RETRY:
    s_add_u32 s62, s61, 4096
    buffer_load_dwordx4 v[32:35], v2, s[28:31], s61 offen offset:0 sc1
    buffer_load_dwordx4 v[36:39], v2, s[28:31], s61 offen offset:1024 sc1
    buffer_load_dwordx4 v[40:43], v2, s[28:31], s61 offen offset:2048 sc1
    buffer_load_dwordx4 v[44:47], v2, s[28:31], s61 offen offset:3072 sc1
    buffer_load_dwordx4 v[48:51], v2, s[28:31], s62 offen offset:0 sc1
    buffer_load_dwordx4 v[52:55], v2, s[28:31], s62 offen offset:1024 sc1
    buffer_load_dwordx4 v[56:59], v2, s[28:31], s62 offen offset:2048 sc1
    buffer_load_dwordx4 v[60:63], v2, s[28:31], s62 offen offset:3072 sc1
S_W0:
    s_waitcnt vmcnt(0)
S_CHK:
    v_cmp_ne_u32 vcc, s3, v34
    v_cmp_ne_u32 s[62:63], s3, v38
    s_or_b64 vcc, vcc, s[62:63]
    v_cmp_ne_u32 s[62:63], s3, v42
    s_or_b64 vcc, vcc, s[62:63]
    v_cmp_ne_u32 s[62:63], s3, v46
    s_or_b64 vcc, vcc, s[62:63]
    v_cmp_ne_u32 s[62:63], s3, v50
    s_or_b64 vcc, vcc, s[62:63]
    v_cmp_ne_u32 s[62:63], s3, v54
    s_or_b64 vcc, vcc, s[62:63]
    v_cmp_ne_u32 s[62:63], s3, v58
    s_or_b64 vcc, vcc, s[62:63]
    v_cmp_ne_u32 s[62:63], s3, v62
    s_or_b64 vcc, vcc, s[62:63]
    s_cmp_eq_u64 vcc, 0
    s_cbranch_scc1 S_OK
    s_add_u32 s60, s60, 1
    s_cmp_lt_u32 s60, 200000
    s_cbranch_scc1 S_RETRY
S_OK:
    s_lshr_b32 s2, s2, 1
    s_add_u32 s2, s2, 50688
    v_lshl_add_u32 v17, v1, 3, s2
    ds_write_b64 v17, v[32:33] offset:0
    ds_write_b64 v17, v[36:37] offset:512
    ds_write_b64 v17, v[40:41] offset:1024
    ds_write_b64 v17, v[44:45] offset:1536
    ds_write_b64 v17, v[48:49] offset:2048
    ds_write_b64 v17, v[52:53] offset:2560
    ds_write_b64 v17, v[56:57] offset:3072
    ds_write_b64 v17, v[60:61] offset:3584
    s_bfe_u32 s58, s54, 0x10001
    s_and_b32 s63, s54, 1
    v_mov_b32 v30, 161280
    v_mov_b32 v23, 4
    s_waitcnt lgkmcnt(0)
    s_mov_b64 exec, 1
    ds_add_u32 v30, v19
    s_mov_b64 exec, -1
    s_lshl_b32 s62, s58, 14
    s_lshl_b32 s59, s63, 12
    s_add_u32 s62, s62, s59
    s_add_u32 s2, s62, 67072
    v_add_u32 v25, s2, v2
    v_lshlrev_b32 v4, 5, v10
    v_lshl_add_u32 v4, v11, 3, v4
    s_lshl_b32 s59, s63, 11
    s_mul_i32 s60, s58, 4608
    s_add_u32 s62, s60, s59
    s_add_u32 s62, s62, 33760
    v_xor_b32 v5, 8, v4
    v_add_u32 v26, s62, v5
    s_lshl_b32 s62, s58, 12
    s_add_u32 s62, s62, s59
    s_add_u32 s62, s62, 42496
    v_add_u32 v27, s62, v4
    s_lshl_b32 s62, s59, 2
    s_add_u32 s62, s62, 50688
    v_lshl_add_u32 v28, v4, 2, s62
    v_lshrrev_b32 v4, 2, v10
    v_and_b32 v5, 1, v11
    v_lshl_add_u32 v4, v5, 2, v4
    s_lshl_b32 s62, s63, 4
    v_add_u32 v4, s62, v4
    v_mul_u32_u24 v4, 57344, v4
    v_and_b32 v5, 3, v10
    v_lshlrev_b32 v5, 5, v5
    v_lshrrev_b32 v7, 1, v11
    v_lshl_add_u32 v5, v7, 4, v5
    s_lshl_b32 s62, s55, 1
    s_add_u32 s62, s62, s58
    s_lshl_b32 s62, s62, 7
    s_add_u32 s62, s62, 4194304
    v_add3_u32 v29, v4, v5, s62
    s_lshl_b32 s62, s14, 16
    s_and_b32 s14, s14, 0xffff0000
    s_cmp_eq_u32 s58, 0
    s_cselect_b32 s14, s62, s14
    s_mov_b32 s62, 0xffff0000
    s_mov_b32 s60, 0
SPIN_5:
    ds_read_b32 v15, v30
    s_waitcnt lgkmcnt(0)
    v_cmp_ne_u32 vcc, v15, v23
    s_cbranch_vccz SPIND_6
    s_sleep 1
    s_add_u32 s60, s60, 1
    s_cmp_lt_u32 s60, 1600000
    s_cbranch_scc1 SPIN_5
SPIND_6:
    s_lshl_b32 s58, s58, 3
    s_add_u32 s58, s58, 161296
    v_and_b32 v30, 1, v1
    v_lshl_add_u32 v30, v30, 2, s58
    v_mov_b32 v21, 161312
    ds_read_b64 v[80:81], v26 offset:0
    ds_read_b64 v[88:89], v27 offset:0
    ds_read_b128 v[96:99], v28 offset:0
    ds_read_b128 v[100:103], v28 offset:16
    ds_read_b64 v[82:83], v26 offset:512
    ds_read_b64 v[90:91], v27 offset:512
    ds_read_b128 v[104:107], v28 offset:2048
    ds_read_b128 v[108:111], v28 offset:2064
    ds_read_b64 v[84:85], v26 offset:1024
    ds_read_b64 v[92:93], v27 offset:1024
    ds_read_b128 v[112:115], v28 offset:4096
    ds_read_b128 v[116:119], v28 offset:4112
    s_waitcnt lgkmcnt(8)
    ds_read_b64 v[86:87], v26 offset:1536
    ds_read_b64 v[94:95], v27 offset:1536
    ds_read_b128 v[120:123], v28 offset:6144
    ds_read_b128 v[124:127], v28 offset:6160
    v_and_b32 v132, s62, v81
    v_lshlrev_b32 v48, 16, v88
    v_mul_f32 v132, s14, v132
    v_fma_f32 v32, v48, v96, v97
    v_fmac_f32 v48, v132, v32
    v_lshlrev_b32 v132, 16, v81
    v_and_b32 v49, s62, v88
    v_mul_f32 v132, s14, v132
    v_fma_f32 v33, v49, v98, v99
    v_fmac_f32 v49, v132, v33
    v_and_b32 v132, s62, v80
    v_lshlrev_b32 v50, 16, v89
    v_mul_f32 v132, s14, v132
    v_fma_f32 v34, v50, v100, v101
    v_fmac_f32 v50, v132, v34
    v_lshlrev_b32 v132, 16, v80
    v_and_b32 v51, s62, v89
    v_mul_f32 v132, s14, v132
    v_fma_f32 v35, v51, v102, v103
    v_fmac_f32 v51, v132, v35
    s_waitcnt lgkmcnt(8)
    v_and_b32 v132, s62, v83
    v_lshlrev_b32 v52, 16, v90
    v_mul_f32 v132, s14, v132
    v_fma_f32 v36, v52, v104, v105
    v_fmac_f32 v52, v132, v36
    v_lshlrev_b32 v132, 16, v83
    v_and_b32 v53, s62, v90
    v_mul_f32 v132, s14, v132
    v_fma_f32 v37, v53, v106, v107
    v_fmac_f32 v53, v132, v37
    v_and_b32 v132, s62, v82
    v_lshlrev_b32 v54, 16, v91
    v_mul_f32 v132, s14, v132
    v_fma_f32 v38, v54, v108, v109
    v_fmac_f32 v54, v132, v38
    v_lshlrev_b32 v132, 16, v82
    v_and_b32 v55, s62, v91
    v_mul_f32 v132, s14, v132
    v_fma_f32 v39, v55, v110, v111
    v_fmac_f32 v55, v132, v39
    s_waitcnt lgkmcnt(4)
    v_and_b32 v132, s62, v85
    v_lshlrev_b32 v56, 16, v92
    v_mul_f32 v132, s14, v132
    v_fma_f32 v40, v56, v112, v113
    v_fmac_f32 v56, v132, v40
    v_lshlrev_b32 v132, 16, v85
    v_and_b32 v57, s62, v92
    v_mul_f32 v132, s14, v132
    v_fma_f32 v41, v57, v114, v115
    v_fmac_f32 v57, v132, v41
    v_and_b32 v132, s62, v84
    v_lshlrev_b32 v58, 16, v93
    v_mul_f32 v132, s14, v132
    v_fma_f32 v42, v58, v116, v117
    v_fmac_f32 v58, v132, v42
    v_lshlrev_b32 v132, 16, v84
    v_and_b32 v59, s62, v93
    v_mul_f32 v132, s14, v132
    v_fma_f32 v43, v59, v118, v119
    v_fmac_f32 v59, v132, v43
    s_waitcnt lgkmcnt(0)
    v_and_b32 v132, s62, v87
    v_lshlrev_b32 v60, 16, v94
    v_mul_f32 v132, s14, v132
    v_fma_f32 v44, v60, v120, v121
    v_fmac_f32 v60, v132, v44
    v_lshlrev_b32 v132, 16, v87
    v_and_b32 v61, s62, v94
    v_mul_f32 v132, s14, v132
    v_fma_f32 v45, v61, v122, v123
    v_fmac_f32 v61, v132, v45
    v_and_b32 v132, s62, v86
    v_lshlrev_b32 v62, 16, v95
    v_mul_f32 v132, s14, v132
    v_fma_f32 v46, v62, v124, v125
    v_fmac_f32 v62, v132, v46
    v_lshlrev_b32 v132, 16, v86
    v_and_b32 v63, s62, v95
    v_mul_f32 v132, s14, v132
    v_fma_f32 v47, v63, v126, v127
    v_fmac_f32 v63, v132, v47
    s_mov_b32 s58, 458752
    s_lshl_b32 s61, s55, 6
    s_add_u32 s61, s61, 13705216
    v_mov_b32 v22, 161284
    v_lshlrev_b32 v20, 14, v1
    s_mov_b32 s60, 0
SPIN_7:
    ds_read_b32 v15, v30
    s_waitcnt lgkmcnt(0)
    v_cmp_ne_u32 vcc, v15, v19
    s_cbranch_vccz SPIND_8
    s_sleep 1
    s_add_u32 s60, s60, 1
    s_cmp_lt_u32 s60, 1600000
    s_cbranch_scc1 SPIN_7
SPIND_8:
    ds_read_b128 v[64:67], v25 offset:0
    ds_read_b128 v[68:71], v25 offset:8192
    ds_read_b128 v[72:75], v25 offset:1024
    ds_read_b128 v[76:79], v25 offset:9216
    ds_read_b128 v[80:83], v25 offset:2048
    ds_read_b128 v[84:87], v25 offset:10240
    ds_read_b128 v[88:91], v25 offset:3072
    ds_read_b128 v[92:95], v25 offset:11264
    s_waitcnt lgkmcnt(6)
    v_add_f32 v64, v64, v68
    v_add_f32 v65, v65, v69
    v_add_f32 v66, v66, v70
    v_add_f32 v67, v67, v71
    v_fmac_f32 v48, v64, v32
    v_fmac_f32 v49, v65, v33
    v_fmac_f32 v50, v66, v34
    v_fmac_f32 v51, v67, v35
    v_cvt_pk_bf16_f32 v96, v48, v49
    v_cvt_pk_bf16_f32 v97, v50, v51
    s_waitcnt lgkmcnt(4)
    v_add_f32 v72, v72, v76
    v_add_f32 v73, v73, v77
    v_add_f32 v74, v74, v78
    v_add_f32 v75, v75, v79
    v_fmac_f32 v52, v72, v36
    v_fmac_f32 v53, v73, v37
    v_fmac_f32 v54, v74, v38
    v_fmac_f32 v55, v75, v39
    v_cvt_pk_bf16_f32 v98, v52, v53
    v_cvt_pk_bf16_f32 v99, v54, v55
    s_nop 1
    v_permlane16_swap_b32 v96, v98
    v_permlane16_swap_b32 v97, v99
    buffer_store_dwordx4 v[96:99], v29, s[28:31], 0 offen sc1
    s_waitcnt lgkmcnt(2)
    v_add_f32 v80, v80, v84
    v_add_f32 v81, v81, v85
    v_add_f32 v82, v82, v86
    v_add_f32 v83, v83, v87
    v_fmac_f32 v56, v80, v40
    v_fmac_f32 v57, v81, v41
    v_fmac_f32 v58, v82, v42
    v_fmac_f32 v59, v83, v43
    v_cvt_pk_bf16_f32 v100, v56, v57
    v_cvt_pk_bf16_f32 v101, v58, v59
    s_waitcnt lgkmcnt(0)
    v_add_f32 v88, v88, v92
    v_add_f32 v89, v89, v93
    v_add_f32 v90, v90, v94
    v_add_f32 v91, v91, v95
    v_fmac_f32 v60, v88, v44
    v_fmac_f32 v61, v89, v45
    v_fmac_f32 v62, v90, v46
    v_fmac_f32 v63, v91, v47
    v_cvt_pk_bf16_f32 v102, v60, v61
    v_cvt_pk_bf16_f32 v103, v62, v63
    s_nop 1
    v_permlane16_swap_b32 v100, v102
    v_permlane16_swap_b32 v101, v103
    buffer_store_dwordx4 v[100:103], v29, s[28:31], s58 offen sc1
    v_lshrrev_b32 v4, 3, v1
    v_mul_u32_u24 v4, 896, v4
    v_and_b32 v5, 7, v1
    v_lshlrev_b32 v5, 4, v5
    v_bfe_u32 v24, v1, 4, 1
    v_lshlrev_b32 v24, 6, v24
    v_xor_b32 v5, v5, v24
    v_add_u32 v24, v4, v5
    v_lshrrev_b32 v4, 3, v1
    v_mul_u32_u24 v4, 128, v4
    v_and_b32 v5, 7, v1
    v_lshlrev_b32 v5, 4, v5
    v_bfe_u32 v14, v1, 4, 1
    v_lshlrev_b32 v14, 6, v14
    v_xor_b32 v5, v5, v14
    v_add_u32 v14, v4, v5
    v_and_b32 v6, 3, v1
    v_bfe_u32 v7, v1, 2, 2
    v_lshrrev_b32 v8, 5, v1
    v_lshl_add_u32 v8, v8, 2, v7
    v_lshlrev_b32 v4, 7, v8
    v_lshrrev_b32 v7, 1, v7
    v_lshlrev_b32 v7, 6, v7
    v_add_u32 v4, v4, v7
    v_bfe_u32 v7, v1, 4, 1
    v_lshl_add_u32 v4, v7, 5, v4
    v_lshl_add_u32 v4, v6, 3, v4
    v_xor_b32 v5, 64, v4
    s_add_u32 s60, s69, 1
    s_and_b32 s60, s60, 3
    s_cselect_b32 s60, 1, -3
    s_mul_i32 s8, s60, 14336
    s_add_u32 s60, s69, 2
    s_and_b32 s60, s60, 3
    s_cselect_b32 s60, 1, -3
    s_mul_i32 s9, s60, 14336
    s_add_u32 s60, s69, 3
    s_and_b32 s60, s60, 3
    s_cselect_b32 s60, 1, -3
    s_mul_i32 s10, s60, 14336
    s_mul_i32 s58, s54, 7168
    v_add_u32 v9, s58, v4
    v_add_u32 v10, s58, v5
    s_mul_i32 s58, s54, 12288
    s_add_u32 s58, s58, 57344
    v_add_u32 v7, s58, v4
    v_add_u32 v8, s58, v5
    s_mul_i32 s60, s69, 14336
    v_add_u32 v4, s60, v4
    v_add_u32 v5, s60, v5
    v_mov_b32 v23, 0
    s_waitcnt vmcnt(0)
    s_mov_b64 exec, 1
    ds_add_rtn_u32 v15, v22, v19
    s_waitcnt lgkmcnt(0)
    v_cmp_ne_u32 vcc, 3, v15
    s_mov_b64 exec, 0xff
    s_mov_b32 s59, s2
    s_cbranch_vccnz HI_NF
    buffer_store_dword v18, v20, s[28:31], s61 offen sc1
    ds_write_b32 v21, v19
HI_NF:
    s_mov_b64 exec, -1
    s_cmp_ge_u32 s53, 28
    s_cbranch_scc1 HELPER
    s_sub_u32 s58, s59, s66
    v_add_u32 v13, s58, v12
    s_mov_b32 s60, 0
SPIN_9:
    ds_read_b32 v15, v21
    s_waitcnt lgkmcnt(0)
    v_cmp_ne_u32 vcc, v15, v19
    s_cbranch_vccz SPIND_10
    s_sleep 1
    s_add_u32 s60, s60, 1
    s_cmp_lt_u32 s60, 1600000
    s_cbranch_scc1 SPIN_9
SPIND_10:
    s_add_u32 s60, s69, 1
    s_and_b32 s60, s60, 3
    s_mul_i32 s4, s60, 401408
    s_add_u32 s60, s69, 2
    s_and_b32 s60, s60, 3
    s_mul_i32 s5, s60, 401408
    s_add_u32 s60, s69, 3
    s_and_b32 s60, s60, 3
    s_mul_i32 s6, s60, 401408
    v_add_u32 v26, 56320, v3
    v_add_u32 v27, 112640, v3
    v_add_u32 v28, 168960, v3
    s_add_u32 m0, s59, 0
    s_add_u32 s67, s4, 0
    buffer_load_dwordx4 v3, s[36:39], s67 offen offset:0 lds
    buffer_load_dwordx4 v26, s[36:39], s67 offen offset:1024 lds
    buffer_load_dwordx4 v27, s[36:39], s67 offen offset:2048 lds
    buffer_load_dwordx4 v28, s[36:39], s67 offen offset:3072 lds
    s_add_u32 m0, s59, 8192
    s_add_u32 s67, s4, 229376
    buffer_load_dwordx4 v3, s[36:39], s67 offen offset:0 lds
    buffer_load_dwordx4 v26, s[36:39], s67 offen offset:1024 lds
    buffer_load_dwordx4 v27, s[36:39], s67 offen offset:2048 lds
    s_add_u32 m0, s59, 11264
    s_add_u32 s67, s5, 0
    buffer_load_dwordx4 v3, s[36:39], s67 offen offset:0 lds
    ds_read_b64_tr_b16 v[144:145], v12 offset:0
    ds_read_b64_tr_b16 v[146:147], v12 offset:512
    ds_read_b64_tr_b16 v[148:149], v12 offset:1024
    ds_read_b64_tr_b16 v[150:151], v12 offset:1536
    ds_read_b64_tr_b16 v[152:153], v12 offset:2048
    ds_read_b64_tr_b16 v[154:155], v12 offset:2560
    ds_read_b64_tr_b16 v[156:157], v12 offset:3072
    ds_read_b64_tr_b16 v[158:159], v12 offset:3584
    ds_read_b64_tr_b16 v[160:161], v12 offset:4096
    ds_read_b64_tr_b16 v[162:163], v12 offset:4608
    ds_read_b64_tr_b16 v[164:165], v12 offset:5120
    ds_read_b64_tr_b16 v[166:167], v12 offset:5632
    ds_read_b64_tr_b16 v[168:169], v12 offset:6144
    ds_read_b64_tr_b16 v[170:171], v12 offset:6656
    s_waitcnt lgkmcnt(6)
    s_add_u32 m0, s66, 0
    s_add_u32 s67, s5, 57344
    buffer_load_dwordx4 v3, s[36:39], s67 offen offset:0 lds
    buffer_load_dwordx4 v26, s[36:39], s67 offen offset:1024 lds
    buffer_load_dwordx4 v27, s[36:39], s67 offen offset:2048 lds
    buffer_load_dwordx4 v28, s[36:39], s67 offen offset:3072 lds
    s_waitcnt lgkmcnt(0)
    s_add_u32 m0, s66, 4096
    s_add_u32 s67, s5, 286720
    buffer_load_dwordx4 v3, s[36:39], s67 offen offset:0 lds
    buffer_load_dwordx4 v26, s[36:39], s67 offen offset:1024 lds
    s_add_u32 m0, s66, 6144
    s_add_u32 s67, s6, 0
    buffer_load_dwordx4 v3, s[36:39], s67 offen offset:0 lds
    s_waitcnt vmcnt(11)
    ds_read_b64_tr_b16 v[172:173], v13 offset:0
    ds_read_b64_tr_b16 v[174:175], v13 offset:512
    ds_read_b64_tr_b16 v[176:177], v13 offset:1024
    ds_read_b64_tr_b16 v[178:179], v13 offset:1536
    ds_read_b64_tr_b16 v[180:181], v13 offset:2048
    ds_read_b64_tr_b16 v[182:183], v13 offset:2560
    ds_read_b64_tr_b16 v[184:185], v13 offset:3072
    ds_read_b64_tr_b16 v[186:187], v13 offset:3584
    s_waitcnt vmcnt(7)
    ds_read_b64_tr_b16 v[188:189], v13 offset:8192
    ds_read_b64_tr_b16 v[190:191], v13 offset:8704
    ds_read_b64_tr_b16 v[192:193], v13 offset:9216
    ds_read_b64_tr_b16 v[194:195], v13 offset:9728
    ds_read_b64_tr_b16 v[196:197], v13 offset:10240
    ds_read_b64_tr_b16 v[198:199], v13 offset:10752
    ds_read_b64_tr_b16 v[200:201], v13 offset:11264
    s_waitcnt lgkmcnt(14)
    ds_read_b64_tr_b16 v[202:203], v13 offset:11776
    s_waitcnt vmcnt(4)
    s_waitcnt lgkmcnt(14)
    ds_read_b64_tr_b16 v[204:205], v12 offset:0
    s_waitcnt lgkmcnt(14)
    ds_read_b64_tr_b16 v[206:207], v12 offset:512
    s_waitcnt lgkmcnt(14)
    ds_read_b64_tr_b16 v[208:209], v12 offset:1024
    s_waitcnt lgkmcnt(14)
    ds_read_b64_tr_b16 v[210:211], v12 offset:1536
    s_waitcnt lgkmcnt(14)
    ds_read_b64_tr_b16 v[212:213], v12 offset:2048
    s_waitcnt lgkmcnt(14)
    ds_read_b64_tr_b16 v[214:215], v12 offset:2560
    s_waitcnt lgkmcnt(0)
    s_add_u32 m0, s66, 0
    s_add_u32 s67, s6, 57344
    buffer_load_dwordx4 v3, s[36:39], s67 offen offset:0 lds
    buffer_load_dwordx4 v26, s[36:39], s67 offen offset:1024 lds
    buffer_load_dwordx4 v27, s[36:39], s67 offen offset:2048 lds
    s_waitcnt vmcnt(4)
    ds_read_b64_tr_b16 v[216:217], v12 offset:3072
    ds_read_b64_tr_b16 v[218:219], v12 offset:3584
    ds_read_b64_tr_b16 v[220:221], v12 offset:4096
    ds_read_b64_tr_b16 v[222:223], v12 offset:4608
    ds_read_b64_tr_b16 v[224:225], v12 offset:5120
    ds_read_b64_tr_b16 v[226:227], v12 offset:5632
    s_waitcnt lgkmcnt(0)
    s_add_u32 m0, s66, 3072
    s_add_u32 s67, s6, 229376
    buffer_load_dwordx4 v3, s[36:39], s67 offen offset:0 lds
    buffer_load_dwordx4 v26, s[36:39], s67 offen offset:1024 lds
    buffer_load_dwordx4 v27, s[36:39], s67 offen offset:2048 lds
RING_J:
    s_lshl_b32 s58, s57, 7
    v_add_u32 v3, s58, v24
    v_add_u32 v6, 6144, v3
    s_mul_i32 s67, s54, 200704
    s_mul_i32 s59, s54, 7168
    s_mul_i32 s66, s54, 12288
    s_add_u32 s66, s66, 57344
    s_mul_i32 s58, s56, 57344
    s_add_u32 s58, s58, s59
    s_add_u32 s58, s58, 4194304
    s_add_u32 s63, s58, 4096
    s_lshl_b32 s61, s52, 7
    s_add_u32 s61, s61, 13844480
    v_mov_b32 v24, 0
    v_mov_b32 v25, 0
    v_mov_b32 v26, 0
    v_mov_b32 v27, 0
    s_lshl_b32 s2, s68, 10
    s_add_u32 s2, s2, 13926400
    s_and_b32 s60, s56, 3
    s_lshl_b32 s60, s60, 1
    s_add_u32 s60, s60, s57
    s_mov_b32 s14, s67
    s_cmp_ge_u32 s60, 7
    s_cselect_b32 s4, 7, 0
    s_sub_u32 s60, s60, s4
    s_lshl_b32 s4, s60, 12
    s_add_u32 s60, s60, 1
    s_cmp_ge_u32 s60, 7
    s_cselect_b32 s5, 7, 0
    s_sub_u32 s60, s60, s5
    s_lshl_b32 s5, s60, 12
    s_add_u32 s60, s60, 1
    s_cmp_ge_u32 s60, 7
    s_cselect_b32 s6, 7, 0
    s_sub_u32 s60, s60, s6
    s_lshl_b32 s6, s60, 12
    s_add_u32 s60, s60, 1
    s_cmp_ge_u32 s60, 7
    s_cselect_b32 s7, 7, 0
    s_sub_u32 s60, s60, s7
    s_lshl_b32 s7, s60, 12
    s_add_u32 s60, s60, 1
    s_cmp_ge_u32 s60, 7
    s_cselect_b32 s11, 7, 0
    s_sub_u32 s60, s60, s11
    s_lshl_b32 s11, s60, 12
    s_add_u32 s60, s60, 1
    s_cmp_ge_u32 s60, 7
    s_cselect_b32 s12, 7, 0
    s_sub_u32 s60, s60, s12
    s_lshl_b32 s12, s60, 12
    s_add_u32 s60, s60, 1
    s_cmp_ge_u32 s60, 7
    s_cselect_b32 s13, 7, 0
    s_sub_u32 s60, s60, s13
    s_lshl_b32 s13, s60, 12
    s_add_u32 s60, s60, 1
    s_cmp_lg_u32 s54, 7
    s_cbranch_scc1 H2_W
    s_mov_b32 s60, 0
POLL_11:
    buffer_load_dword v15, v23, s[28:31], s61 offen sc1
    s_waitcnt vmcnt(0)
    v_cmp_ne_u32 vcc, s3, v15
    s_cbranch_vccz POLLD_12
    s_add_u32 s60, s60, 1
    s_cmp_lt_u32 s60, 24
    s_cbranch_scc1 POLL_11
    s_xor_b32 s61, s61, 2048
    s_cmp_lt_u32 s60, 200000
    s_cbranch_scc1 POLL_11
POLLD_12:
H2_W:
    s_mov_b32 m0, s59
    s_barrier
    buffer_load_dwordx4 v14, s[28:31], s58 offen offset:0 sc1 lds
    buffer_load_dwordx4 v14, s[28:31], s58 offen offset:1024 sc1 lds
    buffer_load_dwordx4 v14, s[28:31], s58 offen offset:2048 sc1 lds
    buffer_load_dwordx4 v14, s[28:31], s58 offen offset:3072 sc1 lds
    s_add_u32 m0, s59, 4096
    s_nop 0
    buffer_load_dwordx4 v14, s[28:31], s63 offen offset:0 sc1 lds
    buffer_load_dwordx4 v14, s[28:31], s63 offen offset:1024 sc1 lds
    buffer_load_dwordx4 v14, s[28:31], s63 offen offset:2048 sc1 lds
    buffer_load_dwordx4 v[16:19], v2, s[28:31], s2 offen sc1
    s_lshl_b32 s60, s56, 9
    s_add_u32 s60, s60, 13860864
    v_lshrrev_b32 v28, 1, v2
    buffer_load_dword v28, v28, s[28:31], s60 offen sc1
    s_waitcnt vmcnt(12)
    ds_read_b64_tr_b16 v[228:229], v12 offset:6144
    ds_read_b64_tr_b16 v[230:231], v12 offset:6656
    ds_read_b64_tr_b16 v[232:233], v12 offset:0
    ds_read_b64_tr_b16 v[234:235], v12 offset:512
    ds_read_b64_tr_b16 v[236:237], v12 offset:1024
    ds_read_b64_tr_b16 v[238:239], v12 offset:1536
    ds_read_b64_tr_b16 v[240:241], v12 offset:2048
    ds_read_b64_tr_b16 v[242:243], v12 offset:2560
    s_waitcnt vmcnt(9)
    ds_read_b64_tr_b16 v[244:245], v12 offset:3072
    ds_read_b64_tr_b16 v[246:247], v12 offset:3584
    ds_read_b64_tr_b16 v[248:249], v12 offset:4096
    ds_read_b64_tr_b16 v[250:251], v12 offset:4608
    ds_read_b64_tr_b16 v[252:253], v12 offset:5120
    ds_read_b64_tr_b16 v[254:255], v12 offset:5632
    s_mov_b32 s62, 0xffff0000
    s_waitcnt vmcnt(8)
    ds_read_b64_tr_b16 v[32:33], v9 offset:0
    s_waitcnt lgkmcnt(14)
    ds_read_b64_tr_b16 v[34:35], v10 offset:0
    s_waitcnt vmcnt(7)
    s_waitcnt lgkmcnt(14)
    ds_read_b64_tr_b16 v[36:37], v9 offset:1024
    s_waitcnt lgkmcnt(14)
    ds_read_b64_tr_b16 v[38:39], v10 offset:1024
    s_waitcnt lgkmcnt(2)
    v_dot2_f32_bf16 v24, v32, s15, v24
    v_dot2_f32_bf16 v26, v32, v32, v26
    v_dot2_f32_bf16 v24, v33, s15, v24
    v_dot2_f32_bf16 v26, v33, v33, v26
    v_dot2_f32_bf16 v25, v34, s15, v25
    v_dot2_f32_bf16 v27, v34, v34, v27
    v_dot2_f32_bf16 v25, v35, s15, v25
    v_dot2_f32_bf16 v27, v35, v35, v27
    s_waitcnt vmcnt(6)
    ds_read_b64_tr_b16 v[40:41], v9 offset:2048
    ds_read_b64_tr_b16 v[42:43], v10 offset:2048
    s_waitcnt lgkmcnt(2)
    v_dot2_f32_bf16 v24, v36, s15, v24
    v_dot2_f32_bf16 v26, v36, v36, v26
    v_dot2_f32_bf16 v24, v37, s15, v24
    v_dot2_f32_bf16 v26, v37, v37, v26
    v_dot2_f32_bf16 v25, v38, s15, v25
    v_dot2_f32_bf16 v27, v38, v38, v27
    v_dot2_f32_bf16 v25, v39, s15, v25
    v_dot2_f32_bf16 v27, v39, v39, v27
    s_waitcnt vmcnt(5)
    ds_read_b64_tr_b16 v[44:45], v9 offset:3072
    ds_read_b64_tr_b16 v[46:47], v10 offset:3072
    s_waitcnt lgkmcnt(2)
    v_dot2_f32_bf16 v24, v40, s15, v24
    v_dot2_f32_bf16 v26, v40, v40, v26
    v_dot2_f32_bf16 v24, v41, s15, v24
    v_dot2_f32_bf16 v26, v41, v41, v26
    v_dot2_f32_bf16 v25, v42, s15, v25
    v_dot2_f32_bf16 v27, v42, v42, v27
    v_dot2_f32_bf16 v25, v43, s15, v25
    v_dot2_f32_bf16 v27, v43, v43, v27
    s_waitcnt vmcnt(4)
    ds_read_b64_tr_b16 v[48:49], v9 offset:4096
    ds_read_b64_tr_b16 v[50:51], v10 offset:4096
    s_waitcnt lgkmcnt(2)
    v_dot2_f32_bf16 v24, v44, s15, v24
    v_dot2_f32_bf16 v26, v44, v44, v26
    v_dot2_f32_bf16 v24, v45, s15, v24
    v_dot2_f32_bf16 v26, v45, v45, v26
    v_dot2_f32_bf16 v25, v46, s15, v25
    v_dot2_f32_bf16 v27, v46, v46, v27
    v_dot2_f32_bf16 v25, v47, s15, v25
    v_dot2_f32_bf16 v27, v47, v47, v27
    s_waitcnt vmcnt(3)
    ds_read_b64_tr_b16 v[52:53], v9 offset:5120
    ds_read_b64_tr_b16 v[54:55], v10 offset:5120
    s_waitcnt lgkmcnt(2)
    v_dot2_f32_bf16 v24, v48, s15, v24
    v_dot2_f32_bf16 v26, v48, v48, v26
    v_dot2_f32_bf16 v24, v49, s15, v24
    v_dot2_f32_bf16 v26, v49, v49, v26
    v_dot2_f32_bf16 v25, v50, s15, v25
    v_dot2_f32_bf16 v27, v50, v50, v27
    v_dot2_f32_bf16 v25, v51, s15, v25
    v_dot2_f32_bf16 v27, v51, v51, v27
    s_waitcnt vmcnt(2)
    ds_read_b64_tr_b16 v[56:57], v9 offset:6144
    ds_read_b64_tr_b16 v[58:59], v10 offset:6144
    s_waitcnt lgkmcnt(2)
    v_dot2_f32_bf16 v24, v52, s15, v24
    v_dot2_f32_bf16 v26, v52, v52, v26
    v_dot2_f32_bf16 v24, v53, s15, v24
    v_dot2_f32_bf16 v26, v53, v53, v26
    v_dot2_f32_bf16 v25, v54, s15, v25
    v_dot2_f32_bf16 v27, v54, v54, v27
    v_dot2_f32_bf16 v25, v55, s15, v25
    v_dot2_f32_bf16 v27, v55, v55, v27
    s_waitcnt lgkmcnt(0)
    v_dot2_f32_bf16 v24, v56, s15, v24
    v_dot2_f32_bf16 v26, v56, v56, v26
    v_dot2_f32_bf16 v24, v57, s15, v24
    v_dot2_f32_bf16 v26, v57, v57, v26
    v_dot2_f32_bf16 v25, v58, s15, v25
    v_dot2_f32_bf16 v27, v58, v58, v27
    v_dot2_f32_bf16 v25, v59, s15, v25
    v_dot2_f32_bf16 v27, v59, v59, v27
    s_lshl_b32 s58, s54, 9
    s_add_u32 s58, s58, 157184
    v_lshl_add_u32 v9, v1, 3, s58
    v_permlane32_swap_b32 v24, v25
    v_permlane32_swap_b32 v26, v27
    v_lshlrev_b32 v15, 3, v1
    v_add_u32 v15, 157184, v15
    v_add_f32 v24, v24, v25
    v_add_f32 v25, v26, v27
    ds_write_b64 v9, v[24:25]
    s_waitcnt lgkmcnt(0)
    s_barrier
    s_setprio 3
    ds_read_b64_tr_b16 v[64:65], v4 offset:0
    ds_read_b64_tr_b16 v[66:67], v4 offset:1024
    ds_read_b64_tr_b16 v[68:69], v4 offset:2048
    ds_read_b64_tr_b16 v[70:71], v4 offset:3072
    ds_read_b64_tr_b16 v[72:73], v4 offset:4096
    ds_read_b64_tr_b16 v[74:75], v4 offset:5120
    s_waitcnt lgkmcnt(2)
    v_mfma_f32_32x32x16_bf16 v[32:47], v[144:147], v[64:67], 0
    ds_read_b64_tr_b16 v[76:77], v4 offset:6144
    ds_read_b64_tr_b16 v[78:79], v4 offset:7168
    s_mul_i32 s67, s4, 7
    s_add_u32 m0, s66, 0
    s_add_u32 s67, s67, s14
    buffer_load_dwordx4 v3, s[40:43], s67 offen lds
    buffer_load_dwordx4 v6, s[40:43], s67 offen offset:1024 lds
    v_mfma_f32_32x32x16_bf16 v[32:47], v[148:151], v[68:71], v[32:47]
    ds_read_b64_tr_b16 v[64:65], v4 offset:8192
    ds_read_b64_tr_b16 v[66:67], v4 offset:9216
    s_waitcnt lgkmcnt(2)
    v_mfma_f32_32x32x16_bf16 v[32:47], v[152:155], v[72:75], v[32:47]
    ds_read_b64_tr_b16 v[68:69], v4 offset:10240
    ds_read_b64_tr_b16 v[70:71], v4 offset:11264
    ds_read_b64 v[48:49], v15 offset:0
    ds_read_b64 v[50:51], v15 offset:512
    ds_read_b64 v[52:53], v15 offset:1024
    ds_read_b64 v[54:55], v15 offset:1536
    ds_read_b64 v[56:57], v15 offset:2048
    ds_read_b64 v[58:59], v15 offset:2560
    ds_read_b64 v[60:61], v15 offset:3072
    ds_read_b64 v[62:63], v15 offset:3584
    s_waitcnt lgkmcnt(0)
    v_add_f32 v48, v48, v50
    v_add_f32 v49, v49, v51
    v_add_f32 v52, v52, v54
    v_add_f32 v53, v53, v55
    v_mfma_f32_32x32x16_bf16 v[32:47], v[156:159], v[76:79], v[32:47]
    ds_read_b64_tr_b16 v[72:73], v4 offset:12288
    ds_read_b64_tr_b16 v[74:75], v4 offset:13312
    s_add_u32 m0, s66, 2048
    s_add_u32 s67, s67, 14336
    buffer_load_dwordx4 v3, s[40:43], s67 offen lds
    buffer_load_dwordx4 v6, s[40:43], s67 offen offset:1024 lds
    v_add_f32 v56, v56, v58
    v_add_f32 v57, v57, v59
    v_add_f32 v60, v60, v62
    v_mfma_f32_32x32x16_bf16 v[32:47], v[160:163], v[64:67], v[32:47]
    v_add_u32 v4, s8, v4
    ds_read_b64_tr_b16 v[76:77], v4 offset:0
    ds_read_b64_tr_b16 v[78:79], v4 offset:1024
    v_add_f32 v61, v61, v63
    v_add_f32 v48, v48, v52
    v_add_f32 v49, v49, v53
    v_add_f32 v56, v56, v60
    v_mfma_f32_32x32x16_bf16 v[32:47], v[164:167], v[68:71], v[32:47]
    ds_read_b64_tr_b16 v[64:65], v4 offset:2048
    ds_read_b64_tr_b16 v[66:67], v4 offset:3072
    v_add_f32 v57, v57, v61
    v_add_f32 v48, v48, v56
    v_add_f32 v49, v49, v57
    s_waitcnt lgkmcnt(2)
    v_mfma_f32_32x32x16_bf16 v[32:47], v[168:171], v[72:75], v[32:47]
    ds_read_b64_tr_b16 v[68:69], v4 offset:4096
    ds_read_b64_tr_b16 v[70:71], v4 offset:5120
    s_mul_i32 s67, s5, 7
    s_add_u32 m0, s66, 4096
    s_add_u32 s67, s67, s14
    buffer_load_dwordx4 v3, s[40:43], s67 offen lds
    buffer_load_dwordx4 v6, s[40:43], s67 offen offset:1024 lds
    v_mul_f32 v48, 0xbb124925, v48
    v_mul_f32 v49, 0x3b124925, v49
    v_fma_f32 v49, -v48, v48, v49
    v_max_f32 v49, 0, v49
    v_mfma_f32_32x32x16_bf16 v[32:47], v[172:175], v[76:79], v[32:47]
    ds_read_b64_tr_b16 v[72:73], v4 offset:6144
    ds_read_b64_tr_b16 v[74:75], v4 offset:7168
    v_add_f32 v50, 0x3727c5ac, v49
    v_rsq_f32 v50, v50
    s_waitcnt lgkmcnt(2)
    v_mfma_f32_32x32x16_bf16 v[32:47], v[176:179], v[64:67], v[32:47]
    ds_read_b64_tr_b16 v[76:77], v4 offset:8192
    ds_read_b64_tr_b16 v[78:79], v4 offset:9216
    v_cvt_pk_bf16_f32 v20, v48, v48
    v_mul_f32 v51, v50, v50
    v_mul_f32 v51, v51, v49
    v_add_f32 v51, 0x3727c5ac, v51
    v_mfma_f32_32x32x16_bf16 v[32:47], v[180:183], v[68:71], v[32:47]
    ds_read_b64_tr_b16 v[64:65], v4 offset:10240
    ds_read_b64_tr_b16 v[66:67], v4 offset:11264
    s_add_u32 m0, s66, 6144
    s_add_u32 s67, s67, 14336
    buffer_load_dwordx4 v3, s[40:43], s67 offen lds
    buffer_load_dwordx4 v6, s[40:43], s67 offen offset:1024 lds
    v_rsq_f32 v51, v51
    v_lshlrev_b32 v52, 16, v20
    s_waitcnt lgkmcnt(2)
    v_mfma_f32_32x32x16_bf16 v[32:47], v[184:187], v[72:75], v[32:47]
    ds_read_b64_tr_b16 v[68:69], v4 offset:12288
    ds_read_b64_tr_b16 v[70:71], v4 offset:13312
    v_mul_f32 v50, v50, v51
    v_sub_f32 v52, v48, v52
    v_rcp_f32 v13, v50
    v_mfma_f32_32x32x16_bf16 v[32:47], v[188:191], v[76:79], v[32:47]
    v_add_u32 v4, s9, v4
    ds_read_b64_tr_b16 v[72:73], v4 offset:0
    ds_read_b64_tr_b16 v[74:75], v4 offset:1024
    v_mul_f32 v9, 0xc0135761, v50
    v_mul_f32 v51, v50, v50
    v_cvt_pk_bf16_f32 v21, v52, v13
    s_waitcnt lgkmcnt(2)
    v_mfma_f32_32x32x16_bf16 v[32:47], v[192:195], v[64:67], v[32:47]
    ds_read_b64_tr_b16 v[76:77], v4 offset:2048
    ds_read_b64_tr_b16 v[78:79], v4 offset:3072
    s_mul_i32 s67, s6, 7
    s_add_u32 m0, s66, 8192
    s_add_u32 s67, s67, s14
    buffer_load_dwordx4 v3, s[40:43], s67 offen lds
    buffer_load_dwordx4 v6, s[40:43], s67 offen offset:1024 lds
    s_waitcnt vmcnt(8)
    ds_read_b64_tr_b16 v[80:81], v7 offset:0
    ds_read_b64_tr_b16 v[82:83], v7 offset:1024
    ds_read_b64_tr_b16 v[84:85], v8 offset:0
    ds_read_b64_tr_b16 v[86:87], v8 offset:1024
    v_mul_f32 v51, 0x3d372713, v51
    v_and_b32 v52, s62, v21
    v_mul_f32 v11, v51, v9
    v_sub_f32 v52, v13, v52
    v_mfma_f32_32x32x16_bf16 v[32:47], v[196:199], v[68:71], v[32:47]
    ds_read_b64_tr_b16 v[64:65], v4 offset:4096
    ds_read_b64_tr_b16 v[66:67], v4 offset:5120
    s_waitcnt vmcnt(6)
    ds_read_b64_tr_b16 v[88:89], v7 offset:2048
    ds_read_b64_tr_b16 v[90:91], v7 offset:3072
    ds_read_b64_tr_b16 v[92:93], v8 offset:2048
    ds_read_b64_tr_b16 v[94:95], v8 offset:3072
    v_mov_b32 v10, v9
    v_mov_b32 v14, v13
    v_cvt_pk_bf16_f32 v22, v52, 0
    s_waitcnt lgkmcnt(10)
    v_mfma_f32_32x32x16_bf16 v[32:47], v[200:203], v[72:75], v[32:47]
    ds_read_b64_tr_b16 v[68:69], v4 offset:6144
    ds_read_b64_tr_b16 v[70:71], v4 offset:7168
    s_waitcnt vmcnt(4)
    ds_read_b64_tr_b16 v[96:97], v7 offset:4096
    ds_read_b64_tr_b16 v[98:99], v7 offset:5120
    ds_read_b64_tr_b16 v[100:101], v8 offset:4096
    s_waitcnt lgkmcnt(14)
    ds_read_b64_tr_b16 v[102:103], v8 offset:5120
    v_mov_b32 v12, v11
    v_permlane32_swap_b32 v9, v10
    v_permlane32_swap_b32 v13, v14
    v_permlane32_swap_b32 v11, v12
    v_mfma_f32_32x32x16_bf16 v[32:47], v[204:207], v[76:79], v[32:47]
    s_waitcnt lgkmcnt(14)
    ds_read_b64_tr_b16 v[72:73], v4 offset:8192
    s_waitcnt lgkmcnt(14)
    ds_read_b64_tr_b16 v[74:75], v4 offset:9216
    s_add_u32 m0, s66, 10240
    s_add_u32 s67, s67, 14336
    buffer_load_dwordx4 v3, s[40:43], s67 offen lds
    buffer_load_dwordx4 v6, s[40:43], s67 offen offset:1024 lds
    s_waitcnt vmcnt(4)
    s_waitcnt lgkmcnt(14)
    ds_read_b64_tr_b16 v[104:105], v7 offset:6144
    s_waitcnt lgkmcnt(14)
    ds_read_b64_tr_b16 v[106:107], v7 offset:7168
    s_waitcnt lgkmcnt(14)
    ds_read_b64_tr_b16 v[108:109], v8 offset:6144
    s_waitcnt lgkmcnt(14)
    ds_read_b64_tr_b16 v[110:111], v8 offset:7168
    s_mul_i32 s61, s56, 229376
    s_lshl_b32 s58, s68, 12
    s_add_u32 s64, s61, 6291456
    s_waitcnt lgkmcnt(10)
    v_mfma_f32_32x32x16_bf16 v[32:47], v[208:211], v[64:67], v[32:47]
    ds_read_b64_tr_b16 v[76:77], v4 offset:10240
    ds_read_b64_tr_b16 v[78:79], v4 offset:11264
    s_add_u32 s61, s64, s58
    s_mul_i32 s59, s54, 28672
    s_add_u32 s64, s64, s59
    s_lshl_b32 s58, s56, 9
    v_mfma_f32_32x32x16_bf16 v[32:47], v[212:215], v[68:71], v[32:47]
    ds_read_b64_tr_b16 v[64:65], v4 offset:12288
    ds_read_b64_tr_b16 v[66:67], v4 offset:13312
    s_add_u32 s63, s58, 13860864
    s_lshl_b32 s65, s68, 2
    s_add_u32 s65, s65, s63
    s_waitcnt lgkmcnt(2)
    v_mfma_f32_32x32x16_bf16 v[32:47], v[216:219], v[72:75], v[32:47]
    v_add_u32 v4, s10, v4
    ds_read_b64_tr_b16 v[68:69], v4 offset:0
    ds_read_b64_tr_b16 v[70:71], v4 offset:1024
    s_waitcnt vmcnt(2)
    ds_read_b64_tr_b16 v[112:113], v7 offset:8192
    ds_read_b64_tr_b16 v[114:115], v7 offset:9216
    ds_read_b64_tr_b16 v[116:117], v8 offset:8192
    ds_read_b64_tr_b16 v[118:119], v8 offset:9216
    s_mul_i32 s67, s7, 7
    s_add_u32 m0, s66, 0
    s_add_u32 s67, s67, s14
    buffer_load_dwordx4 v3, s[40:43], s67 offen lds
    buffer_load_dwordx4 v6, s[40:43], s67 offen offset:1024 lds
    v_mfma_f32_32x32x16_bf16 v[32:47], v[220:223], v[76:79], v[32:47]
    ds_read_b64_tr_b16 v[72:73], v4 offset:2048
    ds_read_b64_tr_b16 v[74:75], v4 offset:3072
    s_waitcnt lgkmcnt(6)
    v_mfma_f32_32x32x16_bf16 v[32:47], v[224:227], v[64:67], v[32:47]
    ds_read_b64_tr_b16 v[76:77], v4 offset:4096
    ds_read_b64_tr_b16 v[78:79], v4 offset:5120
    v_cmp_ne_u32 vcc, s3, v19
    s_cbranch_vccz AUG_OK
    s_mov_b32 s60, 0
AUG_RETRY:
    buffer_load_dwordx4 v[16:19], v2, s[28:31], s2 offen sc1
    s_waitcnt vmcnt(0)
    v_cmp_ne_u32 vcc, s3, v19
    s_cbranch_vccz AUG_OK
    s_add_u32 s60, s60, 1
    s_cmp_lt_u32 s60, 200000
    s_cbranch_scc1 AUG_RETRY
AUG_OK:
    v_mov_b32 v19, 0
    v_mfma_f32_32x32x16_bf16 v[32:47], v[228:231], v[68:71], v[32:47]
    ds_read_b64_tr_b16 v[64:65], v4 offset:6144
    ds_read_b64_tr_b16 v[66:67], v4 offset:7168
    s_waitcnt vmcnt(2)
    ds_read_b64_tr_b16 v[120:121], v7 offset:10240
    ds_read_b64_tr_b16 v[122:123], v7 offset:11264
    ds_read_b64_tr_b16 v[124:125], v8 offset:10240
    ds_read_b64_tr_b16 v[126:127], v8 offset:11264
    s_add_u32 m0, s66, 2048
    s_add_u32 s67, s67, 14336
    buffer_load_dwordx4 v3, s[40:43], s67 offen lds
    buffer_load_dwordx4 v6, s[40:43], s67 offen offset:1024 lds
    s_waitcnt lgkmcnt(6)
    v_mfma_f32_32x32x16_bf16 v[32:47], v[232:235], v[72:75], v[32:47]
    ds_read_b64_tr_b16 v[68:69], v4 offset:8192
    ds_read_b64_tr_b16 v[70:71], v4 offset:9216
    v_mfma_f32_32x32x16_bf16 v[32:47], v[236:239], v[76:79], v[32:47]
    ds_read_b64_tr_b16 v[72:73], v4 offset:10240
    ds_read_b64_tr_b16 v[74:75], v4 offset:11264
    s_waitcnt lgkmcnt(2)
    v_mfma_f32_32x32x16_bf16 v[32:47], v[240:243], v[64:67], v[32:47]
    ds_read_b64_tr_b16 v[76:77], v4 offset:12288
    ds_read_b64_tr_b16 v[78:79], v4 offset:13312
    s_waitcnt vmcnt(2)
    ds_read_b64_tr_b16 v[128:129], v7 offset:0
    ds_read_b64_tr_b16 v[130:131], v7 offset:1024
    ds_read_b64_tr_b16 v[132:133], v8 offset:0
    ds_read_b64_tr_b16 v[134:135], v8 offset:1024
    s_mul_i32 s67, s11, 7
    s_add_u32 m0, s66, 4096
    s_add_u32 s67, s67, s14
    buffer_load_dwordx4 v3, s[40:43], s67 offen lds
    buffer_load_dwordx4 v6, s[40:43], s67 offen offset:1024 lds
    v_mfma_f32_32x32x16_bf16 v[32:47], v[244:247], v[68:71], v[32:47]
    s_waitcnt lgkmcnt(4)
    v_mfma_f32_32x32x16_bf16 v[32:47], v[248:251], v[72:75], v[32:47]
    v_mfma_f32_32x32x16_bf16 v[32:47], v[252:255], v[76:79], v[32:47]
    s_waitcnt vmcnt(2)
    ds_read_b64_tr_b16 v[136:137], v7 offset:2048
    ds_read_b64_tr_b16 v[138:139], v7 offset:3072
    ds_read_b64_tr_b16 v[140:141], v8 offset:2048
    ds_read_b64_tr_b16 v[142:143], v8 offset:3072
    s_add_u32 m0, s66, 6144
    s_add_u32 s67, s67, 14336
    buffer_load_dwordx4 v3, s[40:43], s67 offen lds
    buffer_load_dwordx4 v6, s[40:43], s67 offen offset:1024 lds
    v_mfma_f32_32x32x16_bf16 v[32:47], v[16:19], v[20:23], v[32:47]
    ds_read_b64_tr_b16 v[64:65], v5 offset:0
    ds_read_b64_tr_b16 v[66:67], v5 offset:1024
    ds_read_b64_tr_b16 v[68:69], v5 offset:2048
    ds_read_b64_tr_b16 v[70:71], v5 offset:3072
    ds_read_b64_tr_b16 v[72:73], v5 offset:4096
    ds_read_b64_tr_b16 v[74:75], v5 offset:5120
    s_waitcnt lgkmcnt(2)
    v_mfma_f32_32x32x16_bf16 v[48:63], v[144:147], v[64:67], 0
    ds_read_b64_tr_b16 v[76:77], v5 offset:6144
    ds_read_b64_tr_b16 v[78:79], v5 offset:7168
    v_mfma_f32_32x32x16_bf16 v[48:63], v[148:151], v[68:71], v[48:63]
    ds_read_b64_tr_b16 v[64:65], v5 offset:8192
    ds_read_b64_tr_b16 v[66:67], v5 offset:9216
    s_waitcnt lgkmcnt(2)
    v_mfma_f32_32x32x16_bf16 v[48:63], v[152:155], v[72:75], v[48:63]
    ds_read_b64_tr_b16 v[68:69], v5 offset:10240
    ds_read_b64_tr_b16 v[70:71], v5 offset:11264
    s_mul_i32 s67, s12, 7
    s_add_u32 m0, s66, 8192
    s_add_u32 s67, s67, s14
    buffer_load_dwordx4 v3, s[40:43], s67 offen lds
    buffer_load_dwordx4 v6, s[40:43], s67 offen offset:1024 lds
    v_mov_b32 v15, s3
    v_permlane32_swap_b32 v20, v20
    v_permlane32_swap_b32 v21, v21
    v_permlane32_swap_b32 v22, v22
    v_mul_f32 v24, v32, v32
    v_mul_f32 v25, v33, v33
    v_mul_f32 v26, v34, v34
    v_mul_f32 v27, v35, v35
    v_fma_f32 v24, v24, v11, v9
    v_fma_f32 v25, v25, v11, v9
    v_fma_f32 v26, v26, v11, v9
    v_fma_f32 v27, v27, v11, v9
    v_mul_f32 v24, v24, v32
    v_mfma_f32_32x32x16_bf16 v[48:63], v[156:159], v[76:79], v[48:63]
    ds_read_b64_tr_b16 v[72:73], v5 offset:12288
    ds_read_b64_tr_b16 v[74:75], v5 offset:13312
    s_waitcnt vmcnt(4)
    ds_read_b64_tr_b16 v[144:145], v7 offset:4096
    ds_read_b64_tr_b16 v[146:147], v7 offset:5120
    ds_read_b64_tr_b16 v[148:149], v8 offset:4096
    ds_read_b64_tr_b16 v[150:151], v8 offset:5120
    v_mul_f32 v25, v25, v33
    v_mul_f32 v26, v26, v34
    v_mul_f32 v27, v27, v35
    v_exp_f32 v24, v24
    v_exp_f32 v25, v25
    v_exp_f32 v26, v26
    v_exp_f32 v27, v27
    v_fma_f32 v24, v24, v13, v13
    v_fma_f32 v25, v25, v13, v13
    s_waitcnt lgkmcnt(6)
    v_mfma_f32_32x32x16_bf16 v[48:63], v[160:163], v[64:67], v[48:63]
    v_add_u32 v5, s8, v5
    ds_read_b64_tr_b16 v[76:77], v5 offset:0
    ds_read_b64_tr_b16 v[78:79], v5 offset:1024
    v_fma_f32 v26, v26, v13, v13
    v_fma_f32 v27, v27, v13, v13
    v_rcp_f32 v24, v24
    v_rcp_f32 v25, v25
    v_rcp_f32 v26, v26
    v_rcp_f32 v27, v27
    v_mul_f32 v32, v32, v24
    v_mul_f32 v33, v33, v25
    v_mul_f32 v34, v34, v26
    v_mfma_f32_32x32x16_bf16 v[48:63], v[164:167], v[68:71], v[48:63]
    ds_read_b64_tr_b16 v[64:65], v5 offset:2048
    ds_read_b64_tr_b16 v[66:67], v5 offset:3072
    s_waitcnt vmcnt(2)
    ds_read_b64_tr_b16 v[152:153], v7 offset:6144
    ds_read_b64_tr_b16 v[154:155], v7 offset:7168
    ds_read_b64_tr_b16 v[156:157], v8 offset:6144
    ds_read_b64_tr_b16 v[158:159], v8 offset:7168
    s_add_u32 m0, s66, 10240
    s_add_u32 s67, s67, 14336
    buffer_load_dwordx4 v3, s[40:43], s67 offen lds
    buffer_load_dwordx4 v6, s[40:43], s67 offen offset:1024 lds
    v_mul_f32 v35, v35, v27
    v_cvt_pk_bf16_f32 v32, v32, v33
    v_cvt_pk_bf16_f32 v33, v34, v35
    v_mul_f32 v28, v36, v36
    v_mul_f32 v29, v37, v37
    v_mul_f32 v30, v38, v38
    v_mul_f32 v31, v39, v39
    v_fma_f32 v28, v28, v11, v9
    v_fma_f32 v29, v29, v11, v9
    v_fma_f32 v30, v30, v11, v9
    v_fma_f32 v31, v31, v11, v9
    v_mul_f32 v28, v28, v36
    v_mul_f32 v29, v29, v37
    s_waitcnt lgkmcnt(6)
    v_mfma_f32_32x32x16_bf16 v[48:63], v[168:171], v[72:75], v[48:63]
    ds_read_b64_tr_b16 v[68:69], v5 offset:4096
    ds_read_b64_tr_b16 v[70:71], v5 offset:5120
    v_mul_f32 v30, v30, v38
    v_mul_f32 v31, v31, v39
    v_exp_f32 v28, v28
    v_exp_f32 v29, v29
    v_exp_f32 v30, v30
    v_exp_f32 v31, v31
    v_fma_f32 v28, v28, v13, v13
    v_fma_f32 v29, v29, v13, v13
    v_fma_f32 v30, v30, v13, v13
    v_mfma_f32_32x32x16_bf16 v[48:63], v[172:175], v[76:79], v[48:63]
    ds_read_b64_tr_b16 v[72:73], v5 offset:6144
    ds_read_b64_tr_b16 v[74:75], v5 offset:7168
    v_fma_f32 v31, v31, v13, v13
    v_rcp_f32 v28, v28
    v_rcp_f32 v29, v29
    v_rcp_f32 v30, v30
    v_rcp_f32 v31, v31
    v_mul_f32 v36, v36, v28
    v_mul_f32 v37, v37, v29
    v_mul_f32 v38, v38, v30
    v_mul_f32 v39, v39, v31
    s_waitcnt lgkmcnt(2)
    v_mfma_f32_32x32x16_bf16 v[48:63], v[176:179], v[64:67], v[48:63]
    ds_read_b64_tr_b16 v[76:77], v5 offset:8192
    ds_read_b64_tr_b16 v[78:79], v5 offset:9216
    s_waitcnt vmcnt(2)
    ds_read_b64_tr_b16 v[160:161], v7 offset:8192
    ds_read_b64_tr_b16 v[162:163], v7 offset:9216
    ds_read_b64_tr_b16 v[164:165], v8 offset:8192
    ds_read_b64_tr_b16 v[166:167], v8 offset:9216
    s_mul_i32 s67, s13, 7
    s_add_u32 m0, s66, 0
    s_add_u32 s67, s67, s14
    buffer_load_dwordx4 v3, s[40:43], s67 offen lds
    buffer_load_dwordx4 v6, s[40:43], s67 offen offset:1024 lds
    v_cvt_pk_bf16_f32 v34, v36, v37
    v_cvt_pk_bf16_f32 v35, v38, v39
    buffer_store_dwordx4 v[32:35], v2, s[28:31], s61 offen offset:0 sc1
    v_mul_f32 v24, v40, v40
    v_mul_f32 v25, v41, v41
    v_mul_f32 v26, v42, v42
    v_mul_f32 v27, v43, v43
    v_fma_f32 v24, v24, v11, v9
    v_fma_f32 v25, v25, v11, v9
    v_fma_f32 v26, v26, v11, v9
    v_fma_f32 v27, v27, v11, v9
    v_mul_f32 v24, v24, v40
    v_mul_f32 v25, v25, v41
    v_mul_f32 v26, v26, v42
    v_mfma_f32_32x32x16_bf16 v[48:63], v[180:183], v[68:71], v[48:63]
    ds_read_b64_tr_b16 v[64:65], v5 offset:10240
    ds_read_b64_tr_b16 v[66:67], v5 offset:11264
    v_mul_f32 v27, v27, v43
    v_exp_f32 v24, v24
    v_exp_f32 v25, v25
    v_exp_f32 v26, v26
    v_exp_f32 v27, v27
    v_fma_f32 v24, v24, v13, v13
    v_fma_f32 v25, v25, v13, v13
    v_fma_f32 v26, v26, v13, v13
    v_fma_f32 v27, v27, v13, v13
    s_waitcnt lgkmcnt(6)
    v_mfma_f32_32x32x16_bf16 v[48:63], v[184:187], v[72:75], v[48:63]
    ds_read_b64_tr_b16 v[68:69], v5 offset:12288
    ds_read_b64_tr_b16 v[70:71], v5 offset:13312
    v_rcp_f32 v24, v24
    v_rcp_f32 v25, v25
    v_rcp_f32 v26, v26
    v_rcp_f32 v27, v27
    v_mul_f32 v40, v40, v24
    v_mul_f32 v41, v41, v25
    v_mul_f32 v42, v42, v26
    v_mul_f32 v43, v43, v27
    v_cvt_pk_bf16_f32 v40, v40, v41
    v_mfma_f32_32x32x16_bf16 v[48:63], v[188:191], v[76:79], v[48:63]
    v_add_u32 v5, s9, v5
    ds_read_b64_tr_b16 v[72:73], v5 offset:0
    ds_read_b64_tr_b16 v[74:75], v5 offset:1024
    s_waitcnt vmcnt(3)
    ds_read_b64_tr_b16 v[168:169], v7 offset:10240
    ds_read_b64_tr_b16 v[170:171], v7 offset:11264
    ds_read_b64_tr_b16 v[172:173], v8 offset:10240
    ds_read_b64_tr_b16 v[174:175], v8 offset:11264
    s_add_u32 m0, s66, 2048
    s_add_u32 s67, s67, 14336
    buffer_load_dwordx4 v3, s[40:43], s67 offen lds
    buffer_load_dwordx4 v6, s[40:43], s67 offen offset:1024 lds
    v_cvt_pk_bf16_f32 v41, v42, v43
    v_mul_f32 v28, v44, v44
    v_mul_f32 v29, v45, v45
    v_mul_f32 v30, v46, v46
    v_mul_f32 v31, v47, v47
    v_fma_f32 v28, v28, v11, v9
    v_fma_f32 v29, v29, v11, v9
    v_fma_f32 v30, v30, v11, v9
    v_fma_f32 v31, v31, v11, v9
    v_mul_f32 v28, v28, v44
    v_mul_f32 v29, v29, v45
    v_mul_f32 v30, v30, v46
    v_mul_f32 v31, v31, v47
    s_waitcnt lgkmcnt(6)
    v_mfma_f32_32x32x16_bf16 v[48:63], v[192:195], v[64:67], v[48:63]
    ds_read_b64_tr_b16 v[76:77], v5 offset:2048
    ds_read_b64_tr_b16 v[78:79], v5 offset:3072
    v_exp_f32 v28, v28
    v_exp_f32 v29, v29
    v_exp_f32 v30, v30
    v_exp_f32 v31, v31
    v_fma_f32 v28, v28, v13, v13
    v_fma_f32 v29, v29, v13, v13
    v_fma_f32 v30, v30, v13, v13
    v_fma_f32 v31, v31, v13, v13
    v_rcp_f32 v28, v28
    v_mfma_f32_32x32x16_bf16 v[48:63], v[196:199], v[68:71], v[48:63]
    ds_read_b64_tr_b16 v[64:65], v5 offset:4096
    ds_read_b64_tr_b16 v[66:67], v5 offset:5120
    v_rcp_f32 v29, v29
    v_rcp_f32 v30, v30
    v_rcp_f32 v31, v31
    v_mul_f32 v44, v44, v28
    v_mul_f32 v45, v45, v29
    v_mul_f32 v46, v46, v30
    v_mul_f32 v47, v47, v31
    v_cvt_pk_bf16_f32 v42, v44, v45
    v_cvt_pk_bf16_f32 v43, v46, v47
    s_waitcnt lgkmcnt(2)
    v_mfma_f32_32x32x16_bf16 v[48:63], v[200:203], v[72:75], v[48:63]
    ds_read_b64_tr_b16 v[68:69], v5 offset:6144
    ds_read_b64_tr_b16 v[70:71], v5 offset:7168
    s_waitcnt vmcnt(3)
    ds_read_b64_tr_b16 v[176:177], v7 offset:0
    ds_read_b64_tr_b16 v[178:179], v7 offset:1024
    ds_read_b64_tr_b16 v[180:181], v8 offset:0
    ds_read_b64_tr_b16 v[182:183], v8 offset:1024
    buffer_store_dwordx4 v[40:43], v2, s[28:31], s61 offen offset:2048 sc1
    v_mfma_f32_32x32x16_bf16 v[48:63], v[204:207], v[76:79], v[48:63]
    ds_read_b64_tr_b16 v[72:73], v5 offset:8192
    ds_read_b64_tr_b16 v[74:75], v5 offset:9216
    s_waitcnt vmcnt(0)
    s_mov_b64 exec, 1
    buffer_store_dword v15, v23, s[28:31], s65 offen
    s_add_u32 s65, s65, 16384
    buffer_store_dword v15, v23, s[28:31], s65 offen sc1
    s_mov_b64 exec, -1
    s_setprio 2
    s_waitcnt lgkmcnt(6)
    v_mfma_f32_32x32x16_bf16 v[48:63], v[208:211], v[64:67], v[48:63]
    ds_read_b64_tr_b16 v[76:77], v5 offset:10240
    ds_read_b64_tr_b16 v[78:79], v5 offset:11264
    v_mfma_f32_32x32x16_bf16 v[48:63], v[212:215], v[68:71], v[48:63]
    ds_read_b64_tr_b16 v[64:65], v5 offset:12288
    ds_read_b64_tr_b16 v[66:67], v5 offset:13312
    ds_read_b64_tr_b16 v[184:185], v7 offset:2048
    ds_read_b64_tr_b16 v[186:187], v7 offset:3072
    ds_read_b64_tr_b16 v[188:189], v8 offset:2048
    ds_read_b64_tr_b16 v[190:191], v8 offset:3072
    s_waitcnt lgkmcnt(6)
    v_mfma_f32_32x32x16_bf16 v[48:63], v[216:219], v[72:75], v[48:63]
    v_add_u32 v5, s10, v5
    ds_read_b64_tr_b16 v[68:69], v5 offset:0
    ds_read_b64_tr_b16 v[70:71], v5 offset:1024
    v_mfma_f32_32x32x16_bf16 v[48:63], v[220:223], v[76:79], v[48:63]
    ds_read_b64_tr_b16 v[72:73], v5 offset:2048
    ds_read_b64_tr_b16 v[74:75], v5 offset:3072
    s_waitcnt lgkmcnt(2)
    v_mfma_f32_32x32x16_bf16 v[48:63], v[224:227], v[64:67], v[48:63]
    ds_read_b64_tr_b16 v[76:77], v5 offset:4096
    ds_read_b64_tr_b16 v[78:79], v5 offset:5120
    v_mfma_f32_32x32x16_bf16 v[48:63], v[228:231], v[68:71], v[48:63]
    ds_read_b64_tr_b16 v[64:65], v5 offset:6144
    ds_read_b64_tr_b16 v[66:67], v5 offset:7168
    s_waitcnt lgkmcnt(2)
    v_mfma_f32_32x32x16_bf16 v[48:63], v[232:235], v[72:75], v[48:63]
    ds_read_b64_tr_b16 v[68:69], v5 offset:8192
    ds_read_b64_tr_b16 v[70:71], v5 offset:9216
    s_mul_i32 s59, s54, 28
    v_min_u32 v4, 6, v1
    v_lshl_add_u32 v4, v4, 2, s59
    buffer_load_dword v0, v4, s[28:31], s63 offen sc1
    v_mfma_f32_32x32x16_bf16 v[48:63], v[236:239], v[76:79], v[48:63]
    ds_read_b64_tr_b16 v[72:73], v5 offset:10240
    ds_read_b64_tr_b16 v[74:75], v5 offset:11264
    s_waitcnt lgkmcnt(2)
    v_mfma_f32_32x32x16_bf16 v[48:63], v[240:243], v[64:67], v[48:63]
    ds_read_b64_tr_b16 v[76:77], v5 offset:12288
    ds_read_b64_tr_b16 v[78:79], v5 offset:13312
    v_mfma_f32_32x32x16_bf16 v[48:63], v[244:247], v[68:71], v[48:63]
    s_waitcnt lgkmcnt(0)
    v_mfma_f32_32x32x16_bf16 v[48:63], v[248:251], v[72:75], v[48:63]
    v_mfma_f32_32x32x16_bf16 v[48:63], v[252:255], v[76:79], v[48:63]
    v_mfma_f32_32x32x16_bf16 v[48:63], v[16:19], v[20:23], v[48:63]
    s_andn2_b32 s2, s65, 16384
    s_add_u32 s2, s2, 256
    s_nop 6
    s_setprio 1
    v_mul_f32 v24, v48, v48
    v_mul_f32 v25, v49, v49
    s_waitcnt vmcnt(0)
    v_cmp_ne_u32 vcc, s3, v0
    s_cbranch_vccz PCK_13
    s_mov_b32 s60, 0
POLL_14:
    buffer_load_dword v0, v4, s[28:31], s63 offen sc1
    s_waitcnt vmcnt(0)
    v_cmp_ne_u32 vcc, s3, v0
    s_cbranch_vccz POLLD_15
    s_add_u32 s60, s60, 1
    s_cmp_lt_u32 s60, 24
    s_cbranch_scc1 POLL_14
    s_xor_b32 s63, s63, 16384
    s_cmp_lt_u32 s60, 200000
    s_cbranch_scc1 POLL_14
POLLD_15:
PCK_13:
    s_add_u32 s67, s64, s4
    buffer_load_dwordx4 v[192:195], v2, s[28:31], s67 offen offset:0 sc1
    v_mul_f32 v26, v50, v50
    v_mul_f32 v27, v51, v51
    v_fma_f32 v24, v24, v12, v10
    v_fma_f32 v25, v25, v12, v10
    v_fma_f32 v26, v26, v12, v10
    v_fma_f32 v27, v27, v12, v10
    v_mul_f32 v24, v24, v48
    v_mul_f32 v25, v25, v49
    v_mul_f32 v26, v26, v50
    v_mul_f32 v27, v27, v51
    buffer_load_dwordx4 v[196:199], v2, s[28:31], s67 offen offset:2048 sc1
    v_exp_f32 v24, v24
    v_exp_f32 v25, v25
    v_exp_f32 v26, v26
    v_exp_f32 v27, v27
    v_fma_f32 v24, v24, v14, v14
    v_fma_f32 v25, v25, v14, v14
    v_fma_f32 v26, v26, v14, v14
    v_fma_f32 v27, v27, v14, v14
    v_rcp_f32 v24, v24
    v_rcp_f32 v25, v25
    s_add_u32 s67, s64, s5
    buffer_load_dwordx4 v[200:203], v2, s[28:31], s67 offen offset:0 sc1
    v_rcp_f32 v26, v26
    v_rcp_f32 v27, v27
    v_mul_f32 v48, v48, v24
    v_mul_f32 v49, v49, v25
    v_mul_f32 v50, v50, v26
    v_mul_f32 v51, v51, v27
    v_cvt_pk_bf16_f32 v48, v48, v49
    v_cvt_pk_bf16_f32 v49, v50, v51
    v_mul_f32 v28, v52, v52
    v_mul_f32 v29, v53, v53
    buffer_load_dwordx4 v[204:207], v2, s[28:31], s67 offen offset:2048 sc1
    v_mul_f32 v30, v54, v54
    v_mul_f32 v31, v55, v55
    v_fma_f32 v28, v28, v12, v10
    v_fma_f32 v29, v29, v12, v10
    v_fma_f32 v30, v30, v12, v10
    v_fma_f32 v31, v31, v12, v10
    v_mul_f32 v28, v28, v52
    v_mul_f32 v29, v29, v53
    v_mul_f32 v30, v30, v54
    v_mul_f32 v31, v31, v55
    s_add_u32 s67, s64, s6
    buffer_load_dwordx4 v[208:211], v2, s[28:31], s67 offen offset:0 sc1
    v_exp_f32 v28, v28
    v_exp_f32 v29, v29
    v_exp_f32 v30, v30
    v_exp_f32 v31, v31
    v_fma_f32 v28, v28, v14, v14
    v_fma_f32 v29, v29, v14, v14
    v_fma_f32 v30, v30, v14, v14
    v_fma_f32 v31, v31, v14, v14
    v_rcp_f32 v28, v28
    v_rcp_f32 v29, v29
    buffer_load_dwordx4 v[212:215], v2, s[28:31], s67 offen offset:2048 sc1
    v_rcp_f32 v30, v30
    v_rcp_f32 v31, v31
    v_mul_f32 v52, v52, v28
    v_mul_f32 v53, v53, v29
    v_mul_f32 v54, v54, v30
    v_mul_f32 v55, v55, v31
    v_cvt_pk_bf16_f32 v50, v52, v53
    v_cvt_pk_bf16_f32 v51, v54, v55
    buffer_store_dwordx4 v[48:51], v2, s[28:31], s61 offen offset:1024 sc1
    v_mul_f32 v24, v56, v56
    s_add_u32 s67, s64, s7
    buffer_load_dwordx4 v[216:219], v2, s[28:31], s67 offen offset:0 sc1
    v_mul_f32 v25, v57, v57
    v_mul_f32 v26, v58, v58
    v_mul_f32 v27, v59, v59
    v_fma_f32 v24, v24, v12, v10
    v_fma_f32 v25, v25, v12, v10
    v_fma_f32 v26, v26, v12, v10
    v_fma_f32 v27, v27, v12, v10
    v_mul_f32 v24, v24, v56
    v_mul_f32 v25, v25, v57
    v_mul_f32 v26, v26, v58
    buffer_load_dwordx4 v[220:223], v2, s[28:31], s67 offen offset:2048 sc1
    v_mul_f32 v27, v27, v59
    v_exp_f32 v24, v24
    v_exp_f32 v25, v25
    v_exp_f32 v26, v26
    v_exp_f32 v27, v27
    v_fma_f32 v24, v24, v14, v14
    v_fma_f32 v25, v25, v14, v14
    v_fma_f32 v26, v26, v14, v14
    v_fma_f32 v27, v27, v14, v14
    v_rcp_f32 v24, v24
    s_add_u32 s67, s64, s11
    buffer_load_dwordx4 v[224:227], v2, s[28:31], s67 offen offset:0 sc1
    v_rcp_f32 v25, v25
    v_rcp_f32 v26, v26
    v_rcp_f32 v27, v27
    v_mul_f32 v56, v56, v24
    v_mul_f32 v57, v57, v25
    v_mul_f32 v58, v58, v26
    v_mul_f32 v59, v59, v27
    v_cvt_pk_bf16_f32 v56, v56, v57
    v_cvt_pk_bf16_f32 v57, v58, v59
    v_mul_f32 v28, v60, v60
    buffer_load_dwordx4 v[228:231], v2, s[28:31], s67 offen offset:2048 sc1
    v_mul_f32 v29, v61, v61
    v_mul_f32 v30, v62, v62
    v_mul_f32 v31, v63, v63
    v_fma_f32 v28, v28, v12, v10
    v_fma_f32 v29, v29, v12, v10
    v_fma_f32 v30, v30, v12, v10
    v_fma_f32 v31, v31, v12, v10
    v_mul_f32 v28, v28, v60
    v_mul_f32 v29, v29, v61
    v_mul_f32 v30, v30, v62
    v_mul_f32 v31, v31, v63
    v_exp_f32 v28, v28
    v_exp_f32 v29, v29
    v_exp_f32 v30, v30
    v_exp_f32 v31, v31
    v_fma_f32 v28, v28, v14, v14
    v_fma_f32 v29, v29, v14, v14
    v_fma_f32 v30, v30, v14, v14
    v_fma_f32 v31, v31, v14, v14
    v_rcp_f32 v28, v28
    v_rcp_f32 v29, v29
    v_rcp_f32 v30, v30
    v_rcp_f32 v31, v31
    v_mul_f32 v60, v60, v28
    v_mul_f32 v61, v61, v29
    v_mul_f32 v62, v62, v30
    v_mul_f32 v63, v63, v31
    v_cvt_pk_bf16_f32 v58, v60, v61
    v_cvt_pk_bf16_f32 v59, v62, v63
    buffer_store_dwordx4 v[56:59], v2, s[28:31], s61 offen offset:3072 sc1
    s_setprio 0
    s_add_u32 s67, s64, s12
    buffer_load_dwordx4 v[232:235], v2, s[28:31], s67 offen offset:0 sc1
    buffer_load_dwordx4 v[236:239], v2, s[28:31], s67 offen offset:2048 sc1
    s_andn2_b32 s63, s63, 16384
    s_add_u32 s63, s63, 256
    v_mov_b32 v6, v4
    s_lshl_b32 s59, s54, 6
    v_add_u32 v0, s59, v1
    s_lshl_b32 s61, s57, 3
    s_sub_u32 s58, 57344, s66
    s_add_u32 s61, s61, s54
    s_lshl_b32 s61, s61, 10
    s_sub_u32 s61, s61, s66
    v_add_u32 v10, s61, v7
    v_add_u32 v11, s61, v8
    ds_read_b64_tr_b16 v[24:25], v10 offset:0
    ds_read_b64_tr_b16 v[26:27], v11 offset:0
    v_and_b32 v7, 31, v1
    v_lshrrev_b32 v8, 5, v1
    v_lshlrev_b32 v8, 3, v8
    v_lshl_add_u32 v9, v7, 4, v8
    v_add_u32 v9, s66, v9
    v_lshl_add_u32 v8, v7, 7, v8
    v_add_u32 v8, s66, v8
    v_and_b32 v7, 7, v1
    s_waitcnt lgkmcnt(0)
    ds_write_b64 v9, v[24:25] offset:8192
    ds_write_b64 v9, v[26:27] offset:8704
    v_and_b32 v14, 15, v0
    s_lshl_b32 s59, s57, 7
    v_lshl_add_u32 v3, v14, 3, s59
    buffer_load_dwordx2 v[4:5], v3, s[44:47], 0 offen
    s_add_u32 s67, s64, s13
    buffer_load_dwordx4 v[240:243], v2, s[28:31], s67 offen offset:0 sc1
    s_waitcnt vmcnt(15)
    v_mfma_f32_32x32x16_bf16 v[32:47], v[80:83], v[192:195], 0
    v_mfma_f32_32x32x16_bf16 v[64:79], v[84:87], v[192:195], 0
    buffer_load_dwordx4 v[244:247], v2, s[28:31], s67 offen offset:2048 sc1
    s_waitcnt vmcnt(15)
    v_mfma_f32_32x32x16_bf16 v[32:47], v[88:91], v[196:199], v[32:47]
    v_mfma_f32_32x32x16_bf16 v[64:79], v[92:95], v[196:199], v[64:79]
    s_waitcnt vmcnt(14)
    v_mfma_f32_32x32x16_bf16 v[32:47], v[96:99], v[200:203], v[32:47]
    v_mfma_f32_32x32x16_bf16 v[64:79], v[100:103], v[200:203], v[64:79]
    s_waitcnt vmcnt(13)
    v_mfma_f32_32x32x16_bf16 v[32:47], v[104:107], v[204:207], v[32:47]
    v_mfma_f32_32x32x16_bf16 v[64:79], v[108:111], v[204:207], v[64:79]
    s_waitcnt vmcnt(5)
    s_mov_b64 exec, 1
    buffer_store_dword v15, v23, s[28:31], s2 offen
    s_add_u32 s2, s2, 16384
    buffer_store_dword v15, v23, s[28:31], s2 offen sc1
    s_mov_b64 exec, -1
    v_mfma_f32_32x32x16_bf16 v[32:47], v[112:115], v[208:211], v[32:47]
    v_mfma_f32_32x32x16_bf16 v[64:79], v[116:119], v[208:211], v[64:79]
    v_mfma_f32_32x32x16_bf16 v[32:47], v[120:123], v[212:215], v[32:47]
    v_mfma_f32_32x32x16_bf16 v[64:79], v[124:127], v[212:215], v[64:79]
    v_mfma_f32_32x32x16_bf16 v[32:47], v[128:131], v[216:219], v[32:47]
    v_mfma_f32_32x32x16_bf16 v[64:79], v[132:135], v[216:219], v[64:79]
    v_mfma_f32_32x32x16_bf16 v[32:47], v[136:139], v[220:223], v[32:47]
    v_mfma_f32_32x32x16_bf16 v[64:79], v[140:143], v[220:223], v[64:79]
    buffer_load_dword v12, v6, s[28:31], s63 offen sc1
    v_mfma_f32_32x32x16_bf16 v[32:47], v[144:147], v[224:227], v[32:47]
    v_mfma_f32_32x32x16_bf16 v[64:79], v[148:151], v[224:227], v[64:79]
    v_mfma_f32_32x32x16_bf16 v[32:47], v[152:155], v[228:231], v[32:47]
    v_mfma_f32_32x32x16_bf16 v[64:79], v[156:159], v[228:231], v[64:79]
    s_waitcnt vmcnt(7)
    v_mfma_f32_32x32x16_bf16 v[32:47], v[160:163], v[232:235], v[32:47]
    v_mfma_f32_32x32x16_bf16 v[64:79], v[164:167], v[232:235], v[64:79]
    s_waitcnt vmcnt(0)
    v_cmp_ne_u32 vcc, s3, v12
    s_cbranch_vccz PCK_16
    s_mov_b32 s60, 0
POLL_17:
    buffer_load_dword v12, v6, s[28:31], s63 offen sc1
    s_waitcnt vmcnt(0)
    v_cmp_ne_u32 vcc, s3, v12
    s_cbranch_vccz POLLD_18
    s_add_u32 s60, s60, 1
    s_cmp_lt_u32 s60, 24
    s_cbranch_scc1 POLL_17
    s_xor_b32 s63, s63, 16384
    s_cmp_lt_u32 s60, 200000
    s_cbranch_scc1 POLL_17
POLLD_18:
PCK_16:
    s_add_u32 s67, s64, s4
    buffer_load_dwordx4 v[248:251], v2, s[28:31], s67 offen offset:1024 sc1
    buffer_load_dwordx4 v[252:255], v2, s[28:31], s67 offen offset:3072 sc1
    s_add_u32 s67, s64, s5
    buffer_load_dwordx4 v[192:195], v2, s[28:31], s67 offen offset:1024 sc1
    buffer_load_dwordx4 v[196:199], v2, s[28:31], s67 offen offset:3072 sc1
    s_add_u32 s67, s64, s6
    buffer_load_dwordx4 v[200:203], v2, s[28:31], s67 offen offset:1024 sc1
    buffer_load_dwordx4 v[204:207], v2, s[28:31], s67 offen offset:3072 sc1
    v_mfma_f32_32x32x16_bf16 v[32:47], v[168:171], v[236:239], v[32:47]
    v_mfma_f32_32x32x16_bf16 v[64:79], v[172:175], v[236:239], v[64:79]
    s_add_u32 s67, s64, s7
    buffer_load_dwordx4 v[208:211], v2, s[28:31], s67 offen offset:1024 sc1
    buffer_load_dwordx4 v[212:215], v2, s[28:31], s67 offen offset:3072 sc1
    v_mfma_f32_32x32x16_bf16 v[32:47], v[176:179], v[240:243], v[32:47]
    v_mfma_f32_32x32x16_bf16 v[64:79], v[180:183], v[240:243], v[64:79]
    s_add_u32 s67, s64, s11
    buffer_load_dwordx4 v[216:219], v2, s[28:31], s67 offen offset:1024 sc1
    buffer_load_dwordx4 v[220:223], v2, s[28:31], s67 offen offset:3072 sc1
    v_mfma_f32_32x32x16_bf16 v[32:47], v[184:187], v[244:247], v[32:47]
    v_mfma_f32_32x32x16_bf16 v[64:79], v[188:191], v[244:247], v[64:79]
    s_add_u32 s67, s64, s12
    buffer_load_dwordx4 v[224:227], v2, s[28:31], s67 offen offset:1024 sc1
    buffer_load_dwordx4 v[228:231], v2, s[28:31], s67 offen offset:3072 sc1
    s_add_u32 s67, s64, s13
    buffer_load_dwordx4 v[232:235], v2, s[28:31], s67 offen offset:1024 sc1
    buffer_load_dwordx4 v[236:239], v2, s[28:31], s67 offen offset:3072 sc1
    s_waitcnt vmcnt(13)
    v_mfma_f32_32x32x16_bf16 v[48:63], v[80:83], v[248:251], 0
    s_mov_b32 s58, 57344
    v_lshrrev_b32 v13, 4, v0
    v_bfe_u32 v14, v0, 1, 3
    v_and_b32 v15, 7, v13
    v_xor_b32 v15, v15, v14
    v_mfma_f32_32x32x16_bf16 v[16:31], v[84:87], v[248:251], 0
    v_lshlrev_b32 v10, 7, v13
    v_lshl_add_u32 v10, v15, 4, v10
    v_and_b32 v15, 1, v0
    v_lshlrev_b32 v15, 3, v15
    v_add3_u32 v10, v10, v15, s58
    s_waitcnt vmcnt(12)
    v_mfma_f32_32x32x16_bf16 v[48:63], v[88:91], v[252:255], v[48:63]
    v_mul_u32_u24 v14, 12288, v14
    v_lshl_add_u32 v11, v13, 4, v15
    v_add3_u32 v11, v11, v14, s58
    v_add_u32 v9, 49152, v10
    s_lshl_b32 s59, s56, 6
    v_mfma_f32_32x32x16_bf16 v[16:31], v[92:95], v[252:255], v[16:31]
    v_add_u32 v13, s59, v13
    v_mul_u32_u24 v13, 896, v13
    v_add_u32 v13, v13, v3
    v_xor_b32 v12, 0, v7
    v_lshl_add_u32 v80, v12, 4, v8
    s_waitcnt vmcnt(11)
    v_mfma_f32_32x32x16_bf16 v[48:63], v[96:99], v[192:195], v[48:63]
    v_cvt_pk_bf16_f32 v32, v32, v33
    v_cvt_pk_bf16_f32 v33, v34, v35
    ds_write_b64 v80, v[32:33] offset:0
    v_xor_b32 v12, 1, v7
    v_lshl_add_u32 v81, v12, 4, v8
    v_mfma_f32_32x32x16_bf16 v[16:31], v[100:103], v[192:195], v[16:31]
    v_cvt_pk_bf16_f32 v36, v36, v37
    v_cvt_pk_bf16_f32 v37, v38, v39
    ds_write_b64 v81, v[36:37] offset:0
    v_xor_b32 v12, 2, v7
    v_lshl_add_u32 v82, v12, 4, v8
    v_cvt_pk_bf16_f32 v40, v40, v41
    s_waitcnt vmcnt(10)
    v_mfma_f32_32x32x16_bf16 v[48:63], v[104:107], v[196:199], v[48:63]
    v_cvt_pk_bf16_f32 v41, v42, v43
    ds_write_b64 v82, v[40:41] offset:0
    v_xor_b32 v12, 3, v7
    v_lshl_add_u32 v83, v12, 4, v8
    v_cvt_pk_bf16_f32 v44, v44, v45
    v_cvt_pk_bf16_f32 v45, v46, v47
    v_mfma_f32_32x32x16_bf16 v[16:31], v[108:111], v[196:199], v[16:31]
    ds_write_b64 v83, v[44:45] offset:0
    v_xor_b32 v12, 4, v7
    v_lshl_add_u32 v84, v12, 4, v8
    v_cvt_pk_bf16_f32 v64, v64, v65
    v_cvt_pk_bf16_f32 v65, v66, v67
    ds_write_b64 v84, v[64:65] offset:0
    v_xor_b32 v12, 5, v7
    s_waitcnt vmcnt(9)
    v_mfma_f32_32x32x16_bf16 v[48:63], v[112:115], v[200:203], v[48:63]
    v_lshl_add_u32 v85, v12, 4, v8
    v_cvt_pk_bf16_f32 v68, v68, v69
    v_cvt_pk_bf16_f32 v69, v70, v71
    ds_write_b64 v85, v[68:69] offset:0
    v_xor_b32 v12, 6, v7
    v_mfma_f32_32x32x16_bf16 v[16:31], v[116:119], v[200:203], v[16:31]
    v_lshl_add_u32 v86, v12, 4, v8
    v_cvt_pk_bf16_f32 v72, v72, v73
    v_cvt_pk_bf16_f32 v73, v74, v75
    ds_write_b64 v86, v[72:73] offset:0
    v_xor_b32 v12, 7, v7
    v_lshl_add_u32 v87, v12, 4, v8
    s_waitcnt vmcnt(8)
    v_mfma_f32_32x32x16_bf16 v[48:63], v[120:123], v[204:207], v[48:63]
    v_cvt_pk_bf16_f32 v76, v76, v77
    v_cvt_pk_bf16_f32 v77, v78, v79
    ds_write_b64 v87, v[76:77] offset:0
    s_waitcnt lgkmcnt(0)
    s_barrier
    ds_read_b64 v[32:33], v10 offset:0
    ds_read_b64 v[34:35], v10 offset:12288
    ds_read_b64 v[36:37], v10 offset:24576
    ds_read_b64 v[38:39], v10 offset:36864
    ds_read_b64 v[40:41], v9 offset:0
    ds_read_b64 v[42:43], v9 offset:12288
    ds_read_b64 v[44:45], v9 offset:24576
    ds_read_b64 v[46:47], v9 offset:36864
    ds_read_b64 v[70:71], v11 offset:8192
    v_lshlrev_b32 v64, 16, v4
    v_and_b32 v65, s62, v4
    v_lshlrev_b32 v66, 16, v5
    v_mfma_f32_32x32x16_bf16 v[16:31], v[124:127], v[204:207], v[16:31]
    v_and_b32 v67, s62, v5
    s_waitcnt lgkmcnt(6)
    v_lshlrev_b32 v68, 16, v32
    v_and_b32 v32, s62, v32
    v_add_f32 v64, v64, v68
    v_add_f32 v65, v65, v32
    s_waitcnt vmcnt(7)
    v_mfma_f32_32x32x16_bf16 v[48:63], v[128:131], v[208:211], v[48:63]
    v_lshlrev_b32 v68, 16, v33
    v_and_b32 v33, s62, v33
    v_add_f32 v66, v66, v68
    v_add_f32 v67, v67, v33
    v_lshlrev_b32 v68, 16, v34
    v_mfma_f32_32x32x16_bf16 v[16:31], v[132:135], v[208:211], v[16:31]
    v_and_b32 v34, s62, v34
    v_add_f32 v64, v64, v68
    v_add_f32 v65, v65, v34
    v_lshlrev_b32 v68, 16, v35
    s_waitcnt vmcnt(6)
    v_mfma_f32_32x32x16_bf16 v[48:63], v[136:139], v[212:215], v[48:63]
    v_and_b32 v35, s62, v35
    v_add_f32 v66, v66, v68
    v_add_f32 v67, v67, v35
    v_lshlrev_b32 v68, 16, v36
    v_and_b32 v36, s62, v36
    v_mfma_f32_32x32x16_bf16 v[16:31], v[140:143], v[212:215], v[16:31]
    v_add_f32 v64, v64, v68
    v_add_f32 v65, v65, v36
    v_lshlrev_b32 v68, 16, v37
    v_and_b32 v37, s62, v37
    v_add_f32 v66, v66, v68
    s_waitcnt vmcnt(5)
    v_mfma_f32_32x32x16_bf16 v[48:63], v[144:147], v[216:219], v[48:63]
    v_add_f32 v67, v67, v37
    s_waitcnt lgkmcnt(3)
    v_lshlrev_b32 v68, 16, v38
    v_and_b32 v38, s62, v38
    v_add_f32 v64, v64, v68
    v_add_f32 v65, v65, v38
    v_mfma_f32_32x32x16_bf16 v[16:31], v[148:151], v[216:219], v[16:31]
    v_lshlrev_b32 v68, 16, v39
    v_and_b32 v39, s62, v39
    v_add_f32 v66, v66, v68
    v_add_f32 v67, v67, v39
    s_waitcnt vmcnt(4)
    v_mfma_f32_32x32x16_bf16 v[48:63], v[152:155], v[220:223], v[48:63]
    v_lshlrev_b32 v68, 16, v40
    v_and_b32 v40, s62, v40
    v_add_f32 v64, v64, v68
    v_add_f32 v65, v65, v40
    v_lshlrev_b32 v68, 16, v41
    v_mfma_f32_32x32x16_bf16 v[16:31], v[156:159], v[220:223], v[16:31]
    v_and_b32 v41, s62, v41
    v_add_f32 v66, v66, v68
    v_add_f32 v67, v67, v41
    v_lshlrev_b32 v68, 16, v42
    v_and_b32 v42, s62, v42
    s_waitcnt vmcnt(3)
    v_mfma_f32_32x32x16_bf16 v[48:63], v[160:163], v[224:227], v[48:63]
    v_add_f32 v64, v64, v68
    v_add_f32 v65, v65, v42
    v_lshlrev_b32 v68, 16, v43
    v_and_b32 v43, s62, v43
    v_add_f32 v66, v66, v68
    v_mfma_f32_32x32x16_bf16 v[16:31], v[164:167], v[224:227], v[16:31]
    v_add_f32 v67, v67, v43
    s_waitcnt lgkmcnt(0)
    v_lshlrev_b32 v68, 16, v44
    v_and_b32 v44, s62, v44
    v_add_f32 v64, v64, v68
    v_add_f32 v65, v65, v44
    s_waitcnt vmcnt(2)
    v_mfma_f32_32x32x16_bf16 v[48:63], v[168:171], v[228:231], v[48:63]
    v_lshlrev_b32 v68, 16, v45
    v_and_b32 v45, s62, v45
    v_add_f32 v66, v66, v68
    v_add_f32 v67, v67, v45
    v_mfma_f32_32x32x16_bf16 v[16:31], v[172:175], v[228:231], v[16:31]
    v_lshlrev_b32 v68, 16, v46
    v_and_b32 v46, s62, v46
    v_add_f32 v64, v64, v68
    v_add_f32 v65, v65, v46
    v_lshlrev_b32 v68, 16, v47
    s_waitcnt vmcnt(1)
    v_mfma_f32_32x32x16_bf16 v[48:63], v[176:179], v[232:235], v[48:63]
    v_and_b32 v47, s62, v47
    v_add_f32 v66, v66, v68
    v_add_f32 v67, v67, v47
    v_lshlrev_b32 v68, 16, v70
    v_and_b32 v70, s62, v70
    v_mfma_f32_32x32x16_bf16 v[16:31], v[180:183], v[232:235], v[16:31]
    v_add_f32 v64, v64, v68
    v_add_f32 v65, v65, v70
    v_lshlrev_b32 v68, 16, v71
    v_and_b32 v71, s62, v71
    v_add_f32 v66, v66, v68
    s_waitcnt vmcnt(0)
    v_mfma_f32_32x32x16_bf16 v[48:63], v[184:187], v[236:239], v[48:63]
    v_add_f32 v67, v67, v71
    v_cvt_pk_bf16_f32 v64, v64, v65
    v_cvt_pk_bf16_f32 v65, v66, v67
    s_mov_b32 s59, 0
    v_mfma_f32_32x32x16_bf16 v[16:31], v[188:191], v[236:239], v[16:31]
    buffer_store_dwordx2 v[64:65], v13, s[48:51], s59 offen
    s_mov_b32 s60, 0x3f80
    s_mov_b32 s61, 0x3f800000
    s_nop 7
    v_cvt_pk_bf16_f32 v48, v48, v49
    v_cvt_pk_bf16_f32 v49, v50, v51
    ds_write_b64 v80, v[48:49] offset:4096
    v_cvt_pk_bf16_f32 v52, v52, v53
    v_cvt_pk_bf16_f32 v53, v54, v55
    ds_write_b64 v81, v[52:53] offset:4096
    v_cvt_pk_bf16_f32 v56, v56, v57
    v_cvt_pk_bf16_f32 v57, v58, v59
    ds_write_b64 v82, v[56:57] offset:4096
    v_cvt_pk_bf16_f32 v60, v60, v61
    v_cvt_pk_bf16_f32 v61, v62, v63
    ds_write_b64 v83, v[60:61] offset:4096
    v_cvt_pk_bf16_f32 v16, v16, v17
    v_cvt_pk_bf16_f32 v17, v18, v19
    ds_write_b64 v84, v[16:17] offset:4096
    v_cvt_pk_bf16_f32 v20, v20, v21
    v_cvt_pk_bf16_f32 v21, v22, v23
    ds_write_b64 v85, v[20:21] offset:4096
    v_cvt_pk_bf16_f32 v24, v24, v25
    v_cvt_pk_bf16_f32 v25, v26, v27
    ds_write_b64 v86, v[24:25] offset:4096
    v_cvt_pk_bf16_f32 v28, v28, v29
    v_cvt_pk_bf16_f32 v29, v30, v31
    ds_write_b64 v87, v[28:29] offset:4096
    s_waitcnt lgkmcnt(0)
    s_barrier
    ds_read_b64 v[32:33], v10 offset:4096
    ds_read_b64 v[34:35], v10 offset:16384
    ds_read_b64 v[36:37], v10 offset:28672
    ds_read_b64 v[38:39], v10 offset:40960
    ds_read_b64 v[40:41], v9 offset:4096
    ds_read_b64 v[42:43], v9 offset:16384
    ds_read_b64 v[44:45], v9 offset:28672
    ds_read_b64 v[46:47], v9 offset:40960
    ds_read_b64 v[70:71], v11 offset:8704
    v_lshlrev_b32 v64, 16, v4
    v_and_b32 v65, s62, v4
    v_lshlrev_b32 v66, 16, v5
    v_and_b32 v67, s62, v5
    s_waitcnt lgkmcnt(6)
    v_dot2_f32_bf16 v64, v32, s60, v64
    v_dot2_f32_bf16 v65, v32, s61, v65
    v_dot2_f32_bf16 v66, v33, s60, v66
    v_dot2_f32_bf16 v67, v33, s61, v67
    v_dot2_f32_bf16 v64, v34, s60, v64
    v_dot2_f32_bf16 v65, v34, s61, v65
    v_dot2_f32_bf16 v66, v35, s60, v66
    v_dot2_f32_bf16 v67, v35, s61, v67
    v_dot2_f32_bf16 v64, v36, s60, v64
    v_dot2_f32_bf16 v65, v36, s61, v65
    v_dot2_f32_bf16 v66, v37, s60, v66
    v_dot2_f32_bf16 v67, v37, s61, v67
    s_waitcnt lgkmcnt(3)
    v_dot2_f32_bf16 v64, v38, s60, v64
    v_dot2_f32_bf16 v65, v38, s61, v65
    v_dot2_f32_bf16 v66, v39, s60, v66
    v_dot2_f32_bf16 v67, v39, s61, v67
    v_dot2_f32_bf16 v64, v40, s60, v64
    v_dot2_f32_bf16 v65, v40, s61, v65
    v_dot2_f32_bf16 v66, v41, s60, v66
    v_dot2_f32_bf16 v67, v41, s61, v67
    v_dot2_f32_bf16 v64, v42, s60, v64
    v_dot2_f32_bf16 v65, v42, s61, v65
    v_dot2_f32_bf16 v66, v43, s60, v66
    v_dot2_f32_bf16 v67, v43, s61, v67
    s_waitcnt lgkmcnt(0)
    v_dot2_f32_bf16 v64, v44, s60, v64
    v_dot2_f32_bf16 v65, v44, s61, v65
    v_dot2_f32_bf16 v66, v45, s60, v66
    v_dot2_f32_bf16 v67, v45, s61, v67
    v_dot2_f32_bf16 v64, v46, s60, v64
    v_dot2_f32_bf16 v65, v46, s61, v65
    v_dot2_f32_bf16 v66, v47, s60, v66
    v_dot2_f32_bf16 v67, v47, s61, v67
    v_dot2_f32_bf16 v64, v70, s60, v64
    v_dot2_f32_bf16 v65, v70, s61, v65
    v_dot2_f32_bf16 v66, v71, s60, v66
    v_dot2_f32_bf16 v67, v71, s61, v67
    s_nop 2
    v_cvt_pk_bf16_f32 v64, v64, v65
    v_cvt_pk_bf16_f32 v65, v66, v67
    s_mov_b32 s59, 28672
    buffer_store_dwordx2 v[64:65], v13, s[48:51], s59 offen
    s_endpgm
SLOW1:
    s_mov_b32 s33, 16777216
    s_mov_b32 s34, 16785408
    buffer_store_dwordx4 v[32:35], v23, s[28:31], s33 offen sc1
    buffer_store_dwordx4 v[36:39], v23, s[28:31], s34 offen sc1
    v_mov_b32 v4, 161332
    s_waitcnt vmcnt(0)
    s_barrier
    s_cmp_lg_u32 s54, 7
    s_cbranch_scc1 SLOW1_W
    s_lshl_b32 s33, s53, 2
    s_add_u32 s33, s33, s61
    s_mov_b64 exec, 1
    buffer_store_dword v18, v6, s[28:31], s33 offen offset:2048 sc1
    s_mov_b64 exec, -1
    s_mov_b32 s60, 0
SLOW1_P:
    buffer_load_dword v15, v22, s[28:31], s61 offen sc1
    buffer_load_dword v5, v22, s[28:31], s61 offen offset:2048 sc1
    s_waitcnt vmcnt(0)
    v_mov_b32 v7, 0
    v_cmp_ne_u32 vcc, s32, v15
    s_cbranch_vccz SLOW1_D
    v_mov_b32 v7, 16777216
    v_cmp_ne_u32 vcc, s3, v5
    s_cbranch_vccz SLOW1_D
    s_sleep 4
    s_add_u32 s60, s60, 1
    s_cmp_lt_u32 s60, 200000
    s_cbranch_scc1 SLOW1_P
SLOW1_D:
    ds_write_b32 v4, v7
    s_waitcnt lgkmcnt(0)
SLOW1_W:
    s_barrier
    ds_read_b32 v7, v4
    s_waitcnt lgkmcnt(0)
    v_readfirstlane_b32 s33, v7
    s_add_u32 s2, s2, s33
    s_nop 3
    buffer_load_dwordx4 v2, s[28:31], s2 offen sc1 lds
    s_cmp_lt_u32 s54, 4
    s_cbranch_scc1 LO_BACK
    s_add_u32 s62, s62, s33
    s_branch HI_BACK
XSTAT:
    s_lshl_b32 s63, s2, 3
    s_add_u32 s63, s63, s54
    s_mul_i32 s68, s63, 896
    v_add_u32 v7, s68, v2
    v_cmp_gt_u32 vcc, 56, v1
    v_mov_b32 v9, 0x80000000
    s_mov_b32 s15, 0x3f803f80
    v_cndmask_b32 v7, v9, v7, vcc
    v_mov_b32 v28, 0
    v_mov_b32 v29, 0
    buffer_load_dwordx4 v[16:19], v7, s[24:27], 0 offen
    s_mov_b32 s28, s12
    s_and_b32 s29, s13, 0xffff
    s_mov_b32 s30, 20971520
    s_mov_b32 s31, 0x20000
    s_load_dwordx4 s[4:7], s[0:1], 56
    s_load_dwordx4 s[8:11], s[0:1], 72
    s_load_dwordx2 s[64:65], s[0:1], 88
    v_mov_b32 v6, 0
    s_waitcnt vmcnt(0) lgkmcnt(0)
    s_add_u32 s3, s3, 2654435769
    s_mul_i32 s56, s53, 37
    s_lshr_b32 s56, s56, 8
    s_mul_i32 s57, s56, 7
    s_sub_u32 s57, s53, s57
    s_lshr_b32 s69, s54, 1
    s_add_u32 s69, s69, s56
    s_and_b32 s69, s69, 3
    s_lshl_b32 s60, s52, 2
    s_add_u32 s56, s56, s60
    s_lshl_b32 s68, s57, 3
    s_add_u32 s68, s68, s54
    s_mov_b32 s44, s6
    s_and_b32 s45, s7, 0xffff
    s_mov_b32 s46, 3584
    s_mov_b32 s47, 0x20000
    v_and_b32 v4, 31, v1
    s_lshl_b32 s60, s68, 6
    v_lshl_add_u32 v31, v4, 1, s60
    buffer_load_ushort v31, v31, s[44:47], 0 offen
    s_mov_b32 s44, s10
    s_and_b32 s45, s11, 0xffff
    s_mov_b32 s46, 896
    s_mov_b32 s47, 0x20000
    buffer_load_dwordx4 v[24:27], v2, s[44:47], 0 offen
    v_dot2_f32_bf16 v28, v16, s15, v28
    v_dot2_f32_bf16 v29, v16, v16, v29
    v_dot2_f32_bf16 v28, v17, s15, v28
    v_dot2_f32_bf16 v29, v17, v17, v29
    v_dot2_f32_bf16 v28, v18, s15, v28
    v_dot2_f32_bf16 v29, v18, v18, v29
    v_dot2_f32_bf16 v28, v19, s15, v28
    v_dot2_f32_bf16 v29, v19, v19, v29
    s_nop 2
    v_add_f32_dpp v28, v28, v28 quad_perm:[1,0,3,2] row_mask:0xf bank_mask:0xf
    v_add_f32_dpp v29, v29, v29 quad_perm:[1,0,3,2] row_mask:0xf bank_mask:0xf
    s_nop 0
    v_add_f32_dpp v28, v28, v28 quad_perm:[2,3,0,1] row_mask:0xf bank_mask:0xf
    v_add_f32_dpp v29, v29, v29 quad_perm:[2,3,0,1] row_mask:0xf bank_mask:0xf
    s_nop 0
    v_add_f32_dpp v28, v28, v28 row_half_mirror row_mask:0xf bank_mask:0xf
    v_add_f32_dpp v29, v29, v29 row_half_mirror row_mask:0xf bank_mask:0xf
    s_nop 0
    v_add_f32_dpp v28, v28, v28 row_mirror row_mask:0xf bank_mask:0xf
    v_add_f32_dpp v29, v29, v29 row_mirror row_mask:0xf bank_mask:0xf
    s_nop 0
    v_add_f32_dpp v28, v28, v28 row_bcast:15 row_mask:0xa bank_mask:0xf
    v_add_f32_dpp v29, v29, v29 row_bcast:15 row_mask:0xa bank_mask:0xf
    s_nop 0
    v_add_f32_dpp v28, v28, v28 row_bcast:31 row_mask:0xc bank_mask:0xf
    v_add_f32_dpp v29, v29, v29 row_bcast:31 row_mask:0xc bank_mask:0xf
    s_nop 0
    v_mul_f32 v28, 0x3b124925, v28
    v_mul_f32 v29, 0x3b124925, v29
    v_fma_f32 v29, -v28, v28, v29
    v_max_f32 v29, 0, v29
    v_add_f32 v29, 0x3727c5ac, v29
    v_rsq_f32 v16, v29
    v_mov_b32 v18, s3
    v_mov_b32 v19, s3
    v_mul_f32 v17, -v28, v16
    s_lshl_b32 s63, s63, 4
    s_add_u32 s63, s63, 13631488
    s_mov_b32 exec_lo, 0
    s_mov_b32 exec_hi, 0x80000000
    buffer_store_dwordx4 v[16:19], v6, s[28:31], s63 offen sc1
    s_mov_b64 exec, -1
    s_mov_b32 s36, s4
    s_and_b32 s37, s5, 0xffff
    s_mov_b32 s38, 1605632
    s_mov_b32 s39, 0x20000
    s_mov_b32 s40, s8
    s_and_b32 s41, s9, 0xffff
    s_mov_b32 s42, 1605632
    s_mov_b32 s43, 0x20000
    s_mov_b32 s48, s64
    s_and_b32 s49, s65, 0xffff
    s_mov_b32 s50, 1835008
    s_mov_b32 s51, 0x20000
    v_lshrrev_b32 v5, 2, v1
    v_mul_u32_u24 v5, 3584, v5
    v_and_b32 v7, 3, v1
    v_lshl_add_u32 v3, v7, 4, v5
    s_lshl_b32 s58, s68, 6
    v_add_u32 v3, s58, v3
    v_bfe_u32 v5, v1, 2, 2
    v_lshrrev_b32 v12, 5, v1
    v_lshl_add_u32 v12, v12, 2, v5
    v_lshlrev_b32 v12, 6, v12
    v_bfe_u32 v5, v1, 4, 1
    v_lshl_add_u32 v12, v5, 5, v12
    v_lshl_add_u32 v12, v7, 3, v12
    s_xor_b32 s58, s54, 4
    s_mul_i32 s58, s58, 7168
    s_add_u32 s66, s58, 99840
    v_add_u32 v12, s66, v12
    s_mov_b32 s15, 0x3f803f80
    s_cmp_ge_u32 s53, 28
    s_cbranch_scc1 HELPER
    s_add_u32 s67, s69, 0
    s_and_b32 s67, s67, 3
    s_mul_i32 s67, s67, 401408
    s_add_u32 m0, s66, 0
    s_nop 0
    buffer_load_dwordx4 v3, s[36:39], s67 offen lds
    s_add_u32 m0, s66, 1024
    s_add_u32 s67, s67, 57344
    buffer_load_dwordx4 v3, s[36:39], s67 offen lds
    s_add_u32 m0, s66, 2048
    s_add_u32 s67, s67, 57344
    buffer_load_dwordx4 v3, s[36:39], s67 offen lds
    s_add_u32 m0, s66, 3072
    s_add_u32 s67, s67, 57344
    buffer_load_dwordx4 v3, s[36:39], s67 offen lds
    s_add_u32 m0, s66, 4096
    s_add_u32 s67, s67, 57344
    buffer_load_dwordx4 v3, s[36:39], s67 offen lds
    s_add_u32 m0, s66, 5120
    s_add_u32 s67, s67, 57344
    buffer_load_dwordx4 v3, s[36:39], s67 offen lds
    s_add_u32 m0, s66, 6144
    s_add_u32 s67, s67, 57344
    buffer_load_dwordx4 v3, s[36:39], s67 offen lds
    s_lshl_b32 s59, s54, 13
    s_waitcnt vmcnt(0)
    v_lshrrev_b32 v4, 3, v1
    v_mul_u32_u24 v4, 896, v4
    v_and_b32 v5, 7, v1
    v_lshlrev_b32 v5, 4, v5
    v_bfe_u32 v24, v1, 4, 1
    v_lshlrev_b32 v24, 6, v24
    v_xor_b32 v5, v5, v24
    v_add_u32 v24, v4, v5
    v_lshrrev_b32 v4, 3, v1
    v_mul_u32_u24 v4, 128, v4
    v_and_b32 v5, 7, v1
    v_lshlrev_b32 v5, 4, v5
    v_bfe_u32 v14, v1, 4, 1
    v_lshlrev_b32 v14, 6, v14
    v_xor_b32 v5, v5, v14
    v_add_u32 v14, v4, v5
    v_and_b32 v6, 3, v1
    v_bfe_u32 v7, v1, 2, 2
    v_lshrrev_b32 v8, 5, v1
    v_lshl_add_u32 v8, v8, 2, v7
    v_lshlrev_b32 v4, 7, v8
    v_lshrrev_b32 v7, 1, v7
    v_lshlrev_b32 v7, 6, v7
    v_add_u32 v4, v4, v7
    v_bfe_u32 v7, v1, 4, 1
    v_lshl_add_u32 v4, v7, 5, v4
    v_lshl_add_u32 v4, v6, 3, v4
    v_xor_b32 v5, 64, v4
    s_add_u32 s60, s69, 1
    s_and_b32 s60, s60, 3
    s_cselect_b32 s60, 1, -3
    s_mul_i32 s8, s60, 14336
    s_add_u32 s60, s69, 2
    s_and_b32 s60, s60, 3
    s_cselect_b32 s60, 1, -3
    s_mul_i32 s9, s60, 14336
    s_add_u32 s60, s69, 3
    s_and_b32 s60, s60, 3
    s_cselect_b32 s60, 1, -3
    s_mul_i32 s10, s60, 14336
    s_mul_i32 s58, s54, 7168
    v_add_u32 v9, s58, v4
    v_add_u32 v10, s58, v5
    s_mul_i32 s58, s54, 12288
    s_add_u32 s58, s58, 57344
    v_add_u32 v7, s58, v4
    v_add_u32 v8, s58, v5
    s_mul_i32 s60, s69, 14336
    v_add_u32 v4, s60, v4
    v_add_u32 v5, s60, v5
    v_mov_b32 v23, 0
RING7:
    s_sub_u32 s58, s59, s66
    v_add_u32 v13, s58, v12
    s_add_u32 s60, s69, 1
    s_and_b32 s60, s60, 3
    s_mul_i32 s4, s60, 401408
    s_add_u32 s60, s69, 2
    s_and_b32 s60, s60, 3
    s_mul_i32 s5, s60, 401408
    s_add_u32 s60, s69, 3
    s_and_b32 s60, s60, 3
    s_mul_i32 s6, s60, 401408
    v_add_u32 v26, 56320, v3
    v_add_u32 v27, 112640, v3
    v_add_u32 v28, 168960, v3
    s_add_u32 m0, s59, 0
    s_add_u32 s67, s4, 0
    buffer_load_dwordx4 v3, s[36:39], s67 offen offset:0 lds
    buffer_load_dwordx4 v26, s[36:39], s67 offen offset:1024 lds
    buffer_load_dwordx4 v27, s[36:39], s67 offen offset:2048 lds
    buffer_load_dwordx4 v28, s[36:39], s67 offen offset:3072 lds
    s_add_u32 m0, s59, 4096
    s_add_u32 s67, s4, 229376
    buffer_load_dwordx4 v3, s[36:39], s67 offen offset:0 lds
    buffer_load_dwordx4 v26, s[36:39], s67 offen offset:1024 lds
    buffer_load_dwordx4 v27, s[36:39], s67 offen offset:2048 lds
    s_add_u32 m0, s59, 7168
    s_add_u32 s67, s5, 0
    buffer_load_dwordx4 v3, s[36:39], s67 offen offset:0 lds
    ds_read_b64_tr_b16 v[144:145], v12 offset:0
    ds_read_b64_tr_b16 v[146:147], v12 offset:512
    ds_read_b64_tr_b16 v[148:149], v12 offset:1024
    ds_read_b64_tr_b16 v[150:151], v12 offset:1536
    ds_read_b64_tr_b16 v[152:153], v12 offset:2048
    ds_read_b64_tr_b16 v[154:155], v12 offset:2560
    ds_read_b64_tr_b16 v[156:157], v12 offset:3072
    ds_read_b64_tr_b16 v[158:159], v12 offset:3584
    ds_read_b64_tr_b16 v[160:161], v12 offset:4096
    ds_read_b64_tr_b16 v[162:163], v12 offset:4608
    ds_read_b64_tr_b16 v[164:165], v12 offset:5120
    ds_read_b64_tr_b16 v[166:167], v12 offset:5632
    ds_read_b64_tr_b16 v[168:169], v12 offset:6144
    ds_read_b64_tr_b16 v[170:171], v12 offset:6656
    s_waitcnt lgkmcnt(6)
    s_add_u32 m0, s66, 0
    s_add_u32 s67, s5, 57344
    buffer_load_dwordx4 v3, s[36:39], s67 offen offset:0 lds
    buffer_load_dwordx4 v26, s[36:39], s67 offen offset:1024 lds
    buffer_load_dwordx4 v27, s[36:39], s67 offen offset:2048 lds
    buffer_load_dwordx4 v28, s[36:39], s67 offen offset:3072 lds
    s_waitcnt lgkmcnt(0)
    s_add_u32 m0, s66, 4096
    s_add_u32 s67, s5, 286720
    buffer_load_dwordx4 v3, s[36:39], s67 offen offset:0 lds
    buffer_load_dwordx4 v26, s[36:39], s67 offen offset:1024 lds
    s_add_u32 m0, s66, 6144
    s_add_u32 s67, s6, 0
    buffer_load_dwordx4 v3, s[36:39], s67 offen offset:0 lds
    s_waitcnt vmcnt(11)
    ds_read_b64_tr_b16 v[172:173], v13 offset:0
    ds_read_b64_tr_b16 v[174:175], v13 offset:512
    ds_read_b64_tr_b16 v[176:177], v13 offset:1024
    ds_read_b64_tr_b16 v[178:179], v13 offset:1536
    ds_read_b64_tr_b16 v[180:181], v13 offset:2048
    ds_read_b64_tr_b16 v[182:183], v13 offset:2560
    ds_read_b64_tr_b16 v[184:185], v13 offset:3072
    ds_read_b64_tr_b16 v[186:187], v13 offset:3584
    s_waitcnt vmcnt(7)
    ds_read_b64_tr_b16 v[188:189], v13 offset:4096
    ds_read_b64_tr_b16 v[190:191], v13 offset:4608
    ds_read_b64_tr_b16 v[192:193], v13 offset:5120
    ds_read_b64_tr_b16 v[194:195], v13 offset:5632
    ds_read_b64_tr_b16 v[196:197], v13 offset:6144
    ds_read_b64_tr_b16 v[198:199], v13 offset:6656
    ds_read_b64_tr_b16 v[200:201], v13 offset:7168
    s_waitcnt lgkmcnt(14)
    ds_read_b64_tr_b16 v[202:203], v13 offset:7680
    s_waitcnt vmcnt(4)
    s_waitcnt lgkmcnt(14)
    ds_read_b64_tr_b16 v[204:205], v12 offset:0
    s_waitcnt lgkmcnt(14)
    ds_read_b64_tr_b16 v[206:207], v12 offset:512
    s_waitcnt lgkmcnt(14)
    ds_read_b64_tr_b16 v[208:209], v12 offset:1024
    s_waitcnt lgkmcnt(14)
    ds_read_b64_tr_b16 v[210:211], v12 offset:1536
    s_waitcnt lgkmcnt(14)
    ds_read_b64_tr_b16 v[212:213], v12 offset:2048
    s_waitcnt lgkmcnt(14)
    ds_read_b64_tr_b16 v[214:215], v12 offset:2560
    s_waitcnt lgkmcnt(0)
    s_add_u32 m0, s66, 0
    s_add_u32 s67, s6, 57344
    buffer_load_dwordx4 v3, s[36:39], s67 offen offset:0 lds
    buffer_load_dwordx4 v26, s[36:39], s67 offen offset:1024 lds
    buffer_load_dwordx4 v27, s[36:39], s67 offen offset:2048 lds
    s_waitcnt vmcnt(4)
    ds_read_b64_tr_b16 v[216:217], v12 offset:3072
    ds_read_b64_tr_b16 v[218:219], v12 offset:3584
    ds_read_b64_tr_b16 v[220:221], v12 offset:4096
    ds_read_b64_tr_b16 v[222:223], v12 offset:4608
    ds_read_b64_tr_b16 v[224:225], v12 offset:5120
    ds_read_b64_tr_b16 v[226:227], v12 offset:5632
    s_waitcnt lgkmcnt(0)
    s_add_u32 m0, s66, 3072
    s_add_u32 s67, s6, 229376
    buffer_load_dwordx4 v3, s[36:39], s67 offen offset:0 lds
    buffer_load_dwordx4 v26, s[36:39], s67 offen offset:1024 lds
    buffer_load_dwordx4 v27, s[36:39], s67 offen offset:2048 lds
    s_cmp_ge_u32 s53, 7
    s_cbranch_scc1 RING_J
    s_waitcnt vmcnt(0)
    v_mov_b32 v20, 0
    ds_read_b64_tr_b16 v[228:229], v12 offset:6144
    ds_read_b64_tr_b16 v[230:231], v12 offset:6656
    ds_read_b64_tr_b16 v[232:233], v12 offset:0
    ds_read_b64_tr_b16 v[234:235], v12 offset:512
    ds_read_b64_tr_b16 v[236:237], v12 offset:1024
    ds_read_b64_tr_b16 v[238:239], v12 offset:1536
    ds_read_b64_tr_b16 v[240:241], v12 offset:2048
    ds_read_b64_tr_b16 v[242:243], v12 offset:2560
    ds_read_b64_tr_b16 v[244:245], v12 offset:3072
    ds_read_b64_tr_b16 v[246:247], v12 offset:3584
    ds_read_b64_tr_b16 v[248:249], v12 offset:4096
    ds_read_b64_tr_b16 v[250:251], v12 offset:4608
    ds_read_b64_tr_b16 v[252:253], v12 offset:5120
    ds_read_b64_tr_b16 v[254:255], v12 offset:5632
    s_waitcnt lgkmcnt(0)
    v_dot2_f32_bf16 v20, v144, s15, v20
    v_dot2_f32_bf16 v20, v145, s15, v20
    v_dot2_f32_bf16 v20, v146, s15, v20
    v_dot2_f32_bf16 v20, v147, s15, v20
    v_dot2_f32_bf16 v20, v148, s15, v20
    v_dot2_f32_bf16 v20, v149, s15, v20
    v_dot2_f32_bf16 v20, v150, s15, v20
    v_dot2_f32_bf16 v20, v151, s15, v20
    v_dot2_f32_bf16 v20, v152, s15, v20
    v_dot2_f32_bf16 v20, v153, s15, v20
    v_dot2_f32_bf16 v20, v154, s15, v20
    v_dot2_f32_bf16 v20, v155, s15, v20
    v_dot2_f32_bf16 v20, v156, s15, v20
    v_dot2_f32_bf16 v20, v157, s15, v20
    v_dot2_f32_bf16 v20, v158, s15, v20
    v_dot2_f32_bf16 v20, v159, s15, v20
    v_dot2_f32_bf16 v20, v160, s15, v20
    v_dot2_f32_bf16 v20, v161, s15, v20
    v_dot2_f32_bf16 v20, v162, s15, v20
    v_dot2_f32_bf16 v20, v163, s15, v20
    v_dot2_f32_bf16 v20, v164, s15, v20
    v_dot2_f32_bf16 v20, v165, s15, v20
    v_dot2_f32_bf16 v20, v166, s15, v20
    v_dot2_f32_bf16 v20, v167, s15, v20
    v_dot2_f32_bf16 v20, v168, s15, v20
    v_dot2_f32_bf16 v20, v169, s15, v20
    v_dot2_f32_bf16 v20, v170, s15, v20
    v_dot2_f32_bf16 v20, v171, s15, v20
    v_dot2_f32_bf16 v20, v172, s15, v20
    v_dot2_f32_bf16 v20, v173, s15, v20
    v_dot2_f32_bf16 v20, v174, s15, v20
    v_dot2_f32_bf16 v20, v175, s15, v20
    v_dot2_f32_bf16 v20, v176, s15, v20
    v_dot2_f32_bf16 v20, v177, s15, v20
    v_dot2_f32_bf16 v20, v178, s15, v20
    v_dot2_f32_bf16 v20, v179, s15, v20
    v_dot2_f32_bf16 v20, v180, s15, v20
    v_dot2_f32_bf16 v20, v181, s15, v20
    v_dot2_f32_bf16 v20, v182, s15, v20
    v_dot2_f32_bf16 v20, v183, s15, v20
    v_dot2_f32_bf16 v20, v184, s15, v20
    v_dot2_f32_bf16 v20, v185, s15, v20
    v_dot2_f32_bf16 v20, v186, s15, v20
    v_dot2_f32_bf16 v20, v187, s15, v20
    v_dot2_f32_bf16 v20, v188, s15, v20
    v_dot2_f32_bf16 v20, v189, s15, v20
    v_dot2_f32_bf16 v20, v190, s15, v20
    v_dot2_f32_bf16 v20, v191, s15, v20
    v_dot2_f32_bf16 v20, v192, s15, v20
    v_dot2_f32_bf16 v20, v193, s15, v20
    v_dot2_f32_bf16 v20, v194, s15, v20
    v_dot2_f32_bf16 v20, v195, s15, v20
    v_dot2_f32_bf16 v20, v196, s15, v20
    v_dot2_f32_bf16 v20, v197, s15, v20
    v_dot2_f32_bf16 v20, v198, s15, v20
    v_dot2_f32_bf16 v20, v199, s15, v20
    v_dot2_f32_bf16 v20, v200, s15, v20
    v_dot2_f32_bf16 v20, v201, s15, v20
    v_dot2_f32_bf16 v20, v202, s15, v20
    v_dot2_f32_bf16 v20, v203, s15, v20
    v_dot2_f32_bf16 v20, v204, s15, v20
    v_dot2_f32_bf16 v20, v205, s15, v20
    v_dot2_f32_bf16 v20, v206, s15, v20
    v_dot2_f32_bf16 v20, v207, s15, v20
    v_dot2_f32_bf16 v20, v208, s15, v20
    v_dot2_f32_bf16 v20, v209, s15, v20
    v_dot2_f32_bf16 v20, v210, s15, v20
    v_dot2_f32_bf16 v20, v211, s15, v20
    v_dot2_f32_bf16 v20, v212, s15, v20
    v_dot2_f32_bf16 v20, v213, s15, v20
    v_dot2_f32_bf16 v20, v214, s15, v20
    v_dot2_f32_bf16 v20, v215, s15, v20
    v_dot2_f32_bf16 v20, v216, s15, v20
    v_dot2_f32_bf16 v20, v217, s15, v20
    v_dot2_f32_bf16 v20, v218, s15, v20
    v_dot2_f32_bf16 v20, v219, s15, v20
    v_dot2_f32_bf16 v20, v220, s15, v20
    v_dot2_f32_bf16 v20, v221, s15, v20
    v_dot2_f32_bf16 v20, v222, s15, v20
    v_dot2_f32_bf16 v20, v223, s15, v20
    v_dot2_f32_bf16 v20, v224, s15, v20
    v_dot2_f32_bf16 v20, v225, s15, v20
    v_dot2_f32_bf16 v20, v226, s15, v20
    v_dot2_f32_bf16 v20, v227, s15, v20
    v_dot2_f32_bf16 v20, v228, s15, v20
    v_dot2_f32_bf16 v20, v229, s15, v20
    v_dot2_f32_bf16 v20, v230, s15, v20
    v_dot2_f32_bf16 v20, v231, s15, v20
    v_dot2_f32_bf16 v20, v232, s15, v20
    v_dot2_f32_bf16 v20, v233, s15, v20
    v_dot2_f32_bf16 v20, v234, s15, v20
    v_dot2_f32_bf16 v20, v235, s15, v20
    v_dot2_f32_bf16 v20, v236, s15, v20
    v_dot2_f32_bf16 v20, v237, s15, v20
    v_dot2_f32_bf16 v20, v238, s15, v20
    v_dot2_f32_bf16 v20, v239, s15, v20
    v_dot2_f32_bf16 v20, v240, s15, v20
    v_dot2_f32_bf16 v20, v241, s15, v20
    v_dot2_f32_bf16 v20, v242, s15, v20
    v_dot2_f32_bf16 v20, v243, s15, v20
    v_dot2_f32_bf16 v20, v244, s15, v20
    v_dot2_f32_bf16 v20, v245, s15, v20
    v_dot2_f32_bf16 v20, v246, s15, v20
    v_dot2_f32_bf16 v20, v247, s15, v20
    v_dot2_f32_bf16 v20, v248, s15, v20
    v_dot2_f32_bf16 v20, v249, s15, v20
    v_dot2_f32_bf16 v20, v250, s15, v20
    v_dot2_f32_bf16 v20, v251, s15, v20
    v_dot2_f32_bf16 v20, v252, s15, v20
    v_dot2_f32_bf16 v20, v253, s15, v20
    v_dot2_f32_bf16 v20, v254, s15, v20
    v_dot2_f32_bf16 v20, v255, s15, v20
    s_nop 2
    v_mov_b32 v19, v20
    v_lshlrev_b32 v17, 16, v31
    v_cmp_gt_u32 vcc, 32, v1
    v_permlane32_swap_b32 v20, v19
    s_lshl_b32 s2, s68, 10
    s_add_u32 s2, s2, 13926400
    v_add_f32 v16, v20, v19
    v_cvt_pk_bf16_f32 v19, v16, v17
    v_lshlrev_b32 v20, 16, v19
    v_sub_f32 v20, v16, v20
    v_cvt_pk_bf16_f32 v16, v16, v20
    v_lshrrev_b32 v18, 16, v17
    v_cndmask_b32 v16, 0, v16, vcc
    v_cndmask_b32 v17, 0, v19, vcc
    v_cndmask_b32 v18, 0, v18, vcc
    v_mov_b32 v19, s3
    buffer_store_dwordx4 v[16:19], v2, s[28:31], s2 offen sc1
    s_branch RING_J
HELPER:
    v_mov_b32 v6, 0
    s_cmp_lt_u32 s54, 4
    s_cbranch_scc1 END
    s_cmp_eq_u32 s53, 28
    s_cbranch_scc1 LEADER
    s_sub_u32 s61, s53, 29
    s_lshl_b32 s61, s61, 2
    s_and_b32 s59, s54, 3
    s_add_u32 s61, s61, s59
HSTREAM:
    s_lshr_b32 s58, s61, 3
    s_mul_i32 s58, s58, 14336
    s_and_b32 s59, s61, 7
    s_mul_i32 s59, s59, 200704
    s_add_u32 s58, s58, s59
    buffer_load_dwordx4 v[24:27], v2, s[40:43], s58 offen
    s_add_u32 s58, s58, 1024
    buffer_load_dwordx4 v[24:27], v2, s[40:43], s58 offen
    s_add_u32 s58, s58, 1024
    buffer_load_dwordx4 v[24:27], v2, s[40:43], s58 offen
    s_add_u32 s58, s58, 1024
    buffer_load_dwordx4 v[24:27], v2, s[40:43], s58 offen
    s_add_u32 s58, s58, 1024
    buffer_load_dwordx4 v[24:27], v2, s[40:43], s58 offen
    s_add_u32 s58, s58, 1024
    buffer_load_dwordx4 v[24:27], v2, s[40:43], s58 offen
    s_add_u32 s58, s58, 1024
    buffer_load_dwordx4 v[24:27], v2, s[40:43], s58 offen
    s_add_u32 s58, s58, 1024
    buffer_load_dwordx4 v[24:27], v2, s[40:43], s58 offen
    s_add_u32 s58, s58, 1024
    buffer_load_dwordx4 v[24:27], v2, s[40:43], s58 offen
    s_add_u32 s58, s58, 1024
    buffer_load_dwordx4 v[24:27], v2, s[40:43], s58 offen
    s_add_u32 s58, s58, 1024
    buffer_load_dwordx4 v[24:27], v2, s[40:43], s58 offen
    s_add_u32 s58, s58, 1024
    buffer_load_dwordx4 v[24:27], v2, s[40:43], s58 offen
    s_add_u32 s58, s58, 1024
    buffer_load_dwordx4 v[24:27], v2, s[40:43], s58 offen
    s_add_u32 s58, s58, 1024
    buffer_load_dwordx4 v[24:27], v2, s[40:43], s58 offen
    s_add_u32 s58, s58, 1024
    s_waitcnt vmcnt(14)
    s_add_u32 s61, s61, 12
    s_cmp_lt_u32 s61, 112
    s_cbranch_scc1 HSTREAM
    s_endpgm
LEADER:
    s_cmp_lg_u32 s54, 4
    s_cbranch_scc1 END
    v_lshlrev_b32 v4, 6, v1
    s_lshl_b32 s58, s52, 14
    s_add_u32 s58, s58, 13705216
    s_add_u32 s59, s58, 3584
    s_add_u32 s61, s58, 7168
    s_add_u32 s62, s58, 10752
    s_mov_b32 s60, 0
    s_mov_b32 exec_hi, 0x00ffffff
LPOLL:
    buffer_load_dword v24, v4, s[28:31], s58 offen sc1
    buffer_load_dword v25, v4, s[28:31], s59 offen sc1
    buffer_load_dword v26, v4, s[28:31], s61 offen sc1
    buffer_load_dword v27, v4, s[28:31], s62 offen sc1
    s_waitcnt vmcnt(0)
    v_cmp_ne_u32 vcc, s3, v24
    v_cmp_ne_u32 s[64:65], s3, v25
    s_or_b64 vcc, vcc, s[64:65]
    v_cmp_ne_u32 s[64:65], s3, v26
    s_or_b64 vcc, vcc, s[64:65]
    v_cmp_ne_u32 s[64:65], s3, v27
    s_or_b64 vcc, vcc, s[64:65]
    s_cmp_eq_u64 vcc, 0
    s_cbranch_scc1 LGO
    s_add_u32 s60, s60, 1
    s_cmp_lt_u32 s60, 200000
    s_cbranch_scc1 LPOLL
LGO:
    s_lshl_b32 s58, s52, 7
    s_add_u32 s58, s58, 13844480
    s_mov_b64 exec, 1
    buffer_store_dword v18, v6, s[28:31], s58 offen
    buffer_store_dword v18, v6, s[28:31], s58 offen offset:2048 sc1
    s_cmp_lg_u32 s52, 0
    s_cbranch_scc1 END
    s_mov_b32 s58, 13697024
    buffer_store_dword v18, v6, s[28:31], s58 offen sc1
END:
    s_endpgm
CODE_END:
.section .rodata,"a"
.p2align 6
.amdhsa_kernel sequential_preLN__ssm_conv_h3__mixer_channel_mlp__prompt_kernel
  .amdhsa_next_free_vgpr 256
  .amdhsa_next_free_sgpr 102
  .amdhsa_accum_offset 256
  .amdhsa_group_segment_fixed_size 0
  .amdhsa_kernarg_size 112
  .amdhsa_user_sgpr_count 2
  .amdhsa_user_sgpr_kernarg_segment_ptr 1
  .amdhsa_system_sgpr_workgroup_id_x 1
.end_amdhsa_kernel
```
